```python
import torch

def _softmax(x, axis=-1):
    return torch.softmax(x, dim=axis)
def _gelu(x):
    return torch.nn.functional.gelu(x, approximate="tanh")
def _silu(x):
    return torch.nn.functional.silu(x)
def _sigmoid(x):
    return torch.sigmoid(x)
def _layernorm(x, axis=-1, eps=1e-5):
    m = x.mean(dim=axis, keepdim=True)
    v = x.var(dim=axis, keepdim=True, unbiased=False)
    return (x - m) / torch.sqrt(v + eps)
def _scatter_add(tgt, idx, src, axis=0):
    return tgt.clone().index_add_(axis, idx, src)
def _segment_sum(src, seg, n):
    out = torch.zeros((n,) + src.shape[1:], dtype=src.dtype)
    return out.index_add_(0, seg, src)
def _pad(x, pw):
    flat = tuple(v for pair in reversed(pw) for v in pair)
    return torch.nn.functional.pad(x, flat)

kernel_name = 'standalone__deep_cross_pnn__recsys'

def setup_inputs():

    _w = (lambda a: (lambda t: t.to(torch.bfloat16) if t.is_floating_point() else t)(torch.as_tensor(a)))
    B, F, D, V = 1024, 100, 128, min(1000, 100000)
    H = 4 * D
    return {
        "idx": _w((lambda lo, hi, *s: torch.randint(lo, hi, s))(0, V, B, F).to(torch.int64)),
        "table": _w((lambda *s: torch.randn(*s, dtype=torch.bfloat16) * 3.2)(V, D) * (D ** -0.5)),
        "w_p": _w((lambda *s: torch.randn(*s, dtype=torch.bfloat16) * 0.1)(F * F) * ((F * F) ** -0.5)),
        "w1": _w((lambda *s: torch.randn(*s, dtype=torch.bfloat16) * 3.2)(F * D, H) * ((F * D) ** -0.5)),
        "b1": _w((lambda *s: torch.randn(*s, dtype=torch.bfloat16) * 3.2)(H) * 0.01),
        "w2": _w((lambda *s: torch.randn(*s, dtype=torch.bfloat16) * 0.1)(H) * (H ** -0.5)),
        "b2": _w((lambda *s: torch.randn(*s, dtype=torch.bfloat16) * 0.1)(1) * 0.01),
    }

def reference(idx, table, w_p, w1, b1, w2, b2):
    emb = table[idx]
    B = emb.shape[0]; F = emb.shape[1]; D = emb.shape[2]
    ip = torch.einsum('bid,bjd->bij', emb, emb)
    ip = ip.reshape(B, F * F)
    logit_p = ip @ w_p
    z = emb.reshape(B, F * D)
    h = _gelu(z @ w1 + b1)
    logit_d = h @ w2 + b2
    return logit_p + logit_d
```

```asm
; @launch grid=(256,1,1) block=(256,1,1) lds=162816
.amdgcn_target "amdgcn-amd-amdhsa--gfx950"
.text
.globl standalone__deep_cross_pnn__recsys_kernel
.p2align 12
.p2align 8
.type standalone__deep_cross_pnn__recsys_kernel,@function
standalone__deep_cross_pnn__recsys_kernel:
  s_cmp_ge_u32 s2, 256
  s_cbranch_scc1 Lend
  s_load_dwordx16 s[4:19], s[0:1], 0
  s_load_dwordx4 s[20:23], s[0:1], 64
  s_getpc_b64 s[56:57]
Lpcref:
  v_lshrrev_b32 v192, 6, v0
  s_lshr_b32 s46, s2, 3
  s_lshl_b32 s59, s46, 2
  v_readfirstlane_b32 s44, v192
  v_add_lshl_u32 v192, v192, s59, 7
  v_and_b32 v193, 1, v0
  v_lshl_add_u32 v192, v193, 14, v192
  v_min_u32 v192, Lfin-Lpcref-4, v192
  global_load_dword v9, v192, s[56:57]
  v_and_b32 v1, 63, v0
  s_and_b32 s45, s2, 7
  s_lshr_b32 s47, s45, 1
  s_and_b32 s61, s45, 1
  s_lshl_b32 s48, s61, 2
  s_lshr_b32 s66, s46, 3
  s_add_u32 s48, s48, s66
  s_and_b32 s49, s46, 7
  s_add_u32 s59, s59, s44
  s_mul_i32 s69, s66, 6144
  s_mul_i32 s66, s66, 12288
  s_mul_i32 s67, s49, 51200
  s_lshl_b32 s65, s46, 1
  s_add_u32 s65, s65, s44
  v_lshlrev_b32 v8, 4, v0
  s_lshl_b32 s54, s61, 9
  s_lshl_b32 s60, s47, 15
  s_add_u32 s54, s54, s60
  s_lshl_b32 s61, s48, 7
  s_add_u32 s60, s60, s61
  s_lshl_b32 s61, s44, 19
  s_add_u32 s53, s60, s61
  s_lshr_b32 s60, s46, 1
  s_lshl_b32 s60, s60, 17
  s_add_u32 s54, s54, s60
  s_and_b32 s60, s46, 1
  s_lshl_b32 s60, s60, 14
  s_add_u32 s54, s54, s60
  v_lshrrev_b32 v192, 2, v1
  v_and_b32 v198, 3, v1
  v_lshlrev_b32 v193, 7, v198
  v_lshl_add_u32 v6, v192, 10, v193
  s_cmp_lt_u32 s44, 2
  s_cselect_b32 s60, 21, 30
  s_lshl_b32 s60, s44, s60
  v_add_u32 v199, s60, v6
  s_and_b32 s60, s46, 0
  s_or_b32 s60, s60, s44
  s_cselect_b32 s60, 0, 2.0
  v_or_b32 v203, s60, v199
  s_xor_b32 s60, s60, 2.0
  v_or_b32 v199, s60, v199
  s_lshl_b32 s60, s44, 30
  v_add_u32 v6, s60, v6
  v_lshlrev_b32 v200, 8, v192
  v_lshl_add_u32 v200, v198, 4, v200
  s_lshl_b32 s60, s47, 6
  v_add_u32 v200, s60, v200
  v_lshrrev_b32 v202, 3, v1
  v_lshlrev_b32 v202, 8, v202
  s_xor_b32 s60, s60, 0x80
  s_lshl_b32 s61, s59, 11
  s_add_u32 s61, s61, s60
  s_mov_b32 s3, 4194304
  s_add_u32 s26, s67, 51200
  s_mov_b32 s27, 0x20000
  s_mov_b32 s30, 256000
  s_mov_b32 s31, 0x20000
  s_mov_b32 s38, 13107200
  s_mov_b32 s39, 0x20000
  s_mov_b32 s34, 20000
  s_mov_b32 s35, 0x20000
  s_mov_b32 s42, 4259840
  s_mov_b32 s43, 0x20000
  v_bfe_u32 v192, v1, 4, 1
  v_bfe_u32 v193, v1, 3, 1
  v_lshl_add_u32 v192, v192, 3, v193
  v_and_b32 v194, 7, v1
  v_lshlrev_b32 v194, 4, v194
  v_lshl_add_u32 v192, v192, 10, v194
  v_lshrrev_b32 v194, 5, v1
  v_lshl_add_u32 v2, v194, 18, v192
  v_lshl_add_u32 v14, v194, 14, v192
  v_add_u32 v3, 4096, v2
  v_mov_b32 v4, 0x05040100
  v_mov_b32 v198, 0x03020706
  v_cmp_eq_u32 vcc, 1, v193
  s_add_u32 s50, s53, 16384
  s_add_u32 s51, s53, 131072
  v_cndmask_b32 v4, v4, v198, vcc
  s_add_u32 s52, s53, 147456
  v_mov_b32 v207, 0
  s_add_u32 s62, s67, s66
  s_and_b32 s65, s65, 63
  s_mul_i32 m0, s65, 1040
  s_lshl_b32 s60, s65, 12
  s_waitcnt lgkmcnt(0)
  s_mov_b32 s24, s4
  s_mov_b32 s25, s5
  buffer_load_dwordx4 v[128:131], v8, s[24:27], s62 offen
  s_add_u32 s66, s66, 4096
  s_cmp_eq_u32 s66, 53248
  s_cselect_b32 s66, 0, s66
  s_add_u32 s62, s67, s66
  s_mov_b32 s28, s6
  s_mov_b32 s29, s7
  buffer_load_dwordx4 v200, s[28:31], s60 offen lds
  s_mov_b32 s36, s10
  s_mov_b32 s37, s11
  buffer_load_dword v9, v199, s[36:39], s54 offen
  buffer_load_dwordx4 v[132:135], v8, s[24:27], s62 offen
  s_add_u32 s66, s66, 4096
  s_cmp_eq_u32 s66, 53248
  s_cselect_b32 s66, 0, s66
  s_add_u32 s62, s67, s66
  buffer_load_dwordx4 v[136:139], v8, s[24:27], s62 offen
  s_add_u32 s66, s66, 4096
  s_cmp_eq_u32 s66, 53248
  s_cselect_b32 s66, 0, s66
  s_add_u32 s62, s67, s66
  v_add_u32 v202, s61, v202
  v_add_u32 v203, s54, v203
  global_load_ushort v10, v207, s[16:17]
  s_mov_b32 s32, s8
  s_mov_b32 s33, s9
  s_mov_b32 s40, s22
  s_mov_b32 s41, s23
  s_mov_b64 s[0:1], s[20:21]
  s_add_u32 s54, s54, 4194304
  s_lshl_b32 s98, s59, 7
  s_and_b32 s99, s98, 0x380
  s_load_dword s96, s[20:21], 192
  s_load_dword s3, s[22:23], s3
  s_buffer_load_dwordx2 s[96:97], s[32:35], s98 offset:60
  s_buffer_load_dwordx2 s[96:97], s[32:35], s98 offset:16444
  s_load_dwordx2 s[96:97], s[12:13], s99 offset:60
  s_load_dwordx2 s[96:97], s[14:15], s99 offset:60
  v_lshlrev_b32 v204, 3, v0
  v_add_u32 v204, 88064, v204
  v_mov_b32 v205, 0x00410041
  v_mov_b32 v206, 0x05040100
  s_mul_i32 s59, s46, 6
  s_add_u32 s59, s59, 384
  v_lshrrev_b32 v192, 2, v1
  v_add_u32 v193, s59, v192
  v_lshrrev_b32 v194, 5, v193
  v_lshlrev_b32 v194, 17, v194
  v_and_b32 v197, 31, v193
  v_lshl_add_u32 v194, v197, 10, v194
  v_and_b32 v197, 0x180, v6
  s_lshr_b32 s59, s46, 1
  s_lshl_b32 s59, s59, 17
  s_and_b32 s61, s46, 1
  s_lshl_b32 s61, s61, 14
  s_add_u32 s59, s59, s61
  v_subrev_u32 v197, s59, v197
  v_add_u32 v194, v194, v197
  v_cmp_gt_u32 vcc, 6, v192
  v_mov_b32 v197, 2.0
  s_nop 0
  v_cndmask_b32 v193, v197, v193, vcc
  s_and_b32 s59, s48, 4
  s_add_u32 s59, s59, s44
  s_cmp_eq_u32 s59, 1
  s_cselect_b32 s59, 512, 0
  s_cmp_eq_u32 s48, 3
  s_cselect_b32 s61, 2.0, 0
  v_cmp_gt_u32 vcc, s59, v193
  v_or_b32 v6, s61, v6
  s_nop 0
  v_cndmask_b32 v6, v6, v194, vcc
  v_and_b32 v193, 15, v1
  v_mul_u32_u24 v192, 200, v193
  v_lshrrev_b32 v194, 5, v1
  v_lshlrev_b32 v197, 2, v194
  v_add_u32 v192, v192, v197
  s_lshl_b32 s59, s44, 3
  s_add_u32 s59, s59, 88064
  s_mul_i32 s61, s44, 6
  v_add_u32 v252, s61, v197
  s_lshl_b32 s56, s44, 10
  s_add_u32 s56, s56, 65536
  s_min_u32 s57, s56, 66560
  s_add_u32 s57, s57, 20480
  v_and_b32 v5, 16, v1
  s_add_u32 s61, s44, 0
  s_and_b32 s61, s61, 3
  s_mul_i32 s61, s61, 6400
  s_add_u32 s61, s61, s59
  v_add_u32 v248, s61, v192
  s_add_u32 s61, s44, 1
  s_and_b32 s61, s61, 3
  s_mul_i32 s61, s61, 6400
  s_add_u32 s61, s61, s59
  v_add_u32 v249, s61, v192
  s_add_u32 s61, s44, 2
  s_and_b32 s61, s61, 3
  s_mul_i32 s61, s61, 6400
  s_add_u32 s61, s61, s59
  v_add_u32 v250, s61, v192
  s_add_u32 s61, s44, 3
  s_and_b32 s61, s61, 3
  s_mul_i32 s61, s61, 6400
  s_add_u32 s61, s61, s59
  v_add_u32 v251, s61, v192
  s_lshl_b32 s61, s45, 5
  s_add_u32 s61, s61, s46
  s_lshl_b32 s64, s61, 14
  s_mov_b32 s63, s64
  s_lshl_b32 s61, s61, 2
  s_add_u32 s61, s61, s44
  s_mul_i32 s55, s61, 400
  v_and_b32 v7, 48, v1
  s_mul_i32 s5, s44, 12288
  s_add_u32 s5, s5, 113664
  v_lshrrev_b32 v194, 2, v7
  v_xor_b32 v194, v194, v193
  v_lshlrev_b32 v20, 4, v194
  v_xor_b32 v21, 16, v20
  v_xor_b32 v22, 32, v20
  v_xor_b32 v23, 48, v20
  v_lshrrev_b32 v194, 4, v1
  v_xor_b32 v194, v194, v193
  v_lshlrev_b32 v194, 4, v194
  v_and_b32 v201, 3, v1
  v_lshl_add_u32 v194, v201, 10, v194
  v_lshrrev_b32 v198, 2, v193
  v_lshl_add_u32 v194, v198, 8, v194
  v_add_u32 v0, s5, v194
  v_xor_b32 v253, 64, v0
  v_xor_b32 v254, 0x80, v0
  v_xor_b32 v255, 0xc0, v0
  v_lshl_add_u32 v26, v198, 6, v7
  v_lshl_add_u32 v26, v201, 2, v26
  v_mul_u32_u24 v195, 200, v193
  v_lshrrev_b32 v194, 1, v7
  s_mov_b32 s59, 65536
  v_add3_u32 v195, v195, v194, s59
  v_accvgpr_write_b32 a252, v195
  v_lshrrev_b32 v194, 2, v1
  v_mul_u32_u24 v195, 200, v194
  v_lshlrev_b32 v194, 3, v201
  v_add3_u32 v195, v195, v194, s59
  v_accvgpr_write_b32 a253, v195
  s_mov_b32 s10, 0xaaaaaaaa
  s_mov_b32 s11, 0xaaaaaaaa
  s_mov_b32 s16, 0xcccccccc
  s_mov_b32 s17, 0xcccccccc
  s_mov_b32 s20, 0x00f0000f
  s_mov_b32 s21, 0xf0000f00
  v_mov_b32 v194, 0x3f80
  s_mov_b32 vcc_lo, 0x0f00000f
  s_mov_b32 vcc_hi, 0x0f00000f
  v_cndmask_b32 v198, 0, v194, vcc
  s_lshl_b64 vcc, vcc, 4
  v_cndmask_b32 v194, 0, v194, vcc
  s_mov_b32 vcc_lo, -1
  s_mov_b32 vcc_hi, 0
  v_accvgpr_write_b32 a241, v198
  v_accvgpr_write_b32 a244, v198
  v_accvgpr_write_b32 a243, v194
  v_accvgpr_write_b32 a246, v194
  v_cndmask_b32 v195, 0, v198, vcc
  v_cndmask_b32 v198, v198, v207, vcc
  v_accvgpr_write_b32 a240, v195
  v_accvgpr_write_b32 a245, v198
  v_cndmask_b32 v195, 0, v194, vcc
  v_cndmask_b32 v194, v194, v207, vcc
  v_accvgpr_write_b32 a242, v195
  v_accvgpr_write_b32 a247, v194
  v_mul_u32_u24 v195, 0x5555, v201
  v_xor_b32 v195, 0x44444444, v195
  v_bfe_i32 v194, v1, 2, 1
  v_and_b32 v194, 0xaaaa0000, v194
  v_xor_b32 v195, v194, v195
  v_accvgpr_write_b32 a255, v195
  v_accvgpr_write_b32 a248, -1
  v_accvgpr_write_b32 a249, -1
  v_accvgpr_write_b32 a250, -1
  v_accvgpr_write_b32 a251, -1
  s_lshr_b32 s59, s64, 6
  s_lshl_b32 s61, s44, 6
  s_add_u32 s59, s59, s61
  s_add_u32 s59, s59, 4194304
  v_and_b32 v11, 15, v1
  v_lshl_add_u32 v11, v11, 2, s59
  s_lshl2_add_u32 s61, s49, s44
  s_lshl_b32 s61, s61, 11
  s_add_u32 s61, s61, 4194304
  v_and_b32 v194, 31, v1
  v_lshl_add_u32 v13, v194, 6, s61
  v_lshlrev_b32 v198, 4, v1
  v_and_b32 v15, 0x70, v198
  v_lshl_add_u32 v15, v7, 10, v15
  v_and_b32 v201, 8, v1
  v_lshl_add_u32 v15, v201, 7, v15
  v_accvgpr_write_b32 a254, v198
  s_sub_u32 s59, s44, 0
  s_and_b32 s59, s59, 3
  s_mul_i32 s59, s59, 12288
  s_add_u32 s59, s59, 113664
  v_add_u32 v19, s59, v198
  v_accvgpr_write_b32 a80, v19
  v_lshlrev_b32 v195, 3, v1
  v_add_u32 v194, s59, v195
  v_accvgpr_write_b32 a64, v194
  s_sub_u32 s59, s44, 1
  s_and_b32 s59, s59, 3
  s_mul_i32 s59, s59, 12288
  s_add_u32 s59, s59, 113664
  v_add_u32 v16, s59, v198
  v_accvgpr_write_b32 a81, v16
  s_sub_u32 s59, s44, 2
  s_and_b32 s59, s59, 3
  s_mul_i32 s59, s59, 12288
  s_add_u32 s59, s59, 113664
  v_add_u32 v17, s59, v198
  v_accvgpr_write_b32 a82, v17
  s_sub_u32 s59, s44, 3
  s_and_b32 s59, s59, 3
  s_mul_i32 s59, s59, 12288
  s_add_u32 s59, s59, 113664
  v_add_u32 v18, s59, v195
  v_accvgpr_write_b32 a83, v18
  v_lshlrev_b32 v1, 2, v193
  buffer_load_dwordx4 v[140:143], v8, s[24:27], s62 offen
  s_add_u32 s66, s66, 4096
  s_cmp_eq_u32 s66, 53248
  s_cselect_b32 s66, 0, s66
  s_add_u32 s62, s67, s66
  buffer_load_dwordx4 v[144:147], v8, s[24:27], s62 offen
  s_add_u32 s66, s66, 4096
  s_cmp_eq_u32 s66, 53248
  s_cselect_b32 s66, 0, s66
  s_add_u32 s62, s67, s66
  buffer_load_dwordx4 v[148:151], v8, s[24:27], s62 offen
  s_add_u32 s66, s66, 4096
  s_cmp_eq_u32 s66, 53248
  s_cselect_b32 s66, 0, s66
  s_add_u32 s62, s67, s66
  buffer_load_dwordx4 v[152:155], v8, s[24:27], s62 offen
  s_add_u32 s66, s66, 4096
  s_cmp_eq_u32 s66, 53248
  s_cselect_b32 s66, 0, s66
  s_add_u32 s62, s67, s66
  buffer_load_dwordx4 v[156:159], v8, s[24:27], s62 offen
  s_add_u32 s66, s66, 4096
  s_cmp_eq_u32 s66, 53248
  s_cselect_b32 s66, 0, s66
  s_add_u32 s62, s67, s66
  buffer_load_dwordx4 v[160:163], v8, s[24:27], s62 offen
  s_add_u32 s66, s66, 4096
  s_cmp_eq_u32 s66, 53248
  s_cselect_b32 s66, 0, s66
  s_add_u32 s62, s67, s66
  s_mov_b64 exec, 0
  s_cmp_eq_u32 s44, 0
  s_cbranch_scc1 Lsh0
  s_cmp_eq_u32 s44, 1
  s_cbranch_scc1 Lsh1
  s_cmp_eq_u32 s44, 2
  s_cbranch_scc1 Lsh2
  s_branch Lsh3
Lret:
  s_mov_b64 exec, -1
  buffer_load_dwordx4 v[164:167], v8, s[24:27], s62 offen
  s_add_u32 s66, s66, 4096
  s_cmp_eq_u32 s66, 53248
  s_cselect_b32 s66, 0, s66
  s_add_u32 s62, s67, s66
  buffer_load_dwordx4 v[168:171], v8, s[24:27], s62 offen
  s_add_u32 s66, s66, 4096
  s_cmp_eq_u32 s66, 53248
  s_cselect_b32 s66, 0, s66
  s_add_u32 s62, s67, s66
  buffer_load_dwordx4 v[172:175], v8, s[24:27], s62 offen
  s_add_u32 s66, s66, 4096
  s_cmp_eq_u32 s66, 53248
  s_cselect_b32 s66, 0, s66
  s_add_u32 s62, s67, s66
  buffer_load_dwordx4 v[176:179], v8, s[24:27], s62 offen
  s_add_u32 s65, s65, 4
  s_and_b32 s65, s65, 63
  s_mul_i32 m0, s65, 1040
  s_lshl_b32 s60, s65, 12
  buffer_load_dwordx4 v200, s[28:31], s60 offen lds
  s_add_u32 s65, s65, 4
  s_and_b32 s65, s65, 63
  s_mul_i32 m0, s65, 1040
  s_lshl_b32 s60, s65, 12
  buffer_load_dwordx4 v200, s[28:31], s60 offen lds
  s_mov_b32 s26, 409600
  s_waitcnt vmcnt(17)
  v_perm_b32 v128, v129, v128, v206
  v_perm_b32 v129, v131, v130, v206
  v_add_u32 v130, s69, v204
  v_pk_mul_lo_u16 v128, v128, v205
  v_pk_mul_lo_u16 v129, v129, v205
  s_add_u32 s69, s69, 2048
  v_and_b32 v128, 0xfff0fff0, v128
  s_cmp_eq_u32 s69, 26624
  v_and_b32 v129, 0xfff0fff0, v129
  s_cselect_b32 s69, 0, s69
  ds_write_b64 v130, v[128:129]
  s_add_u32 s65, s65, 4
  s_and_b32 s65, s65, 63
  s_mul_i32 m0, s65, 1040
  s_lshl_b32 s60, s65, 12
  buffer_load_dwordx4 v200, s[28:31], s60 offen lds
  s_waitcnt vmcnt(15)
  v_perm_b32 v132, v133, v132, v206
  v_perm_b32 v133, v135, v134, v206
  v_add_u32 v134, s69, v204
  v_pk_mul_lo_u16 v132, v132, v205
  v_pk_mul_lo_u16 v133, v133, v205
  s_add_u32 s69, s69, 2048
  v_and_b32 v132, 0xfff0fff0, v132
  s_cmp_eq_u32 s69, 26624
  v_and_b32 v133, 0xfff0fff0, v133
  s_cselect_b32 s69, 0, s69
  ds_write_b64 v134, v[132:133]
  s_add_u32 s65, s65, 4
  s_and_b32 s65, s65, 63
  s_mul_i32 m0, s65, 1040
  s_lshl_b32 s60, s65, 12
  buffer_load_dwordx4 v200, s[28:31], s60 offen lds
  s_waitcnt vmcnt(15)
  v_perm_b32 v136, v137, v136, v206
  v_perm_b32 v137, v139, v138, v206
  v_add_u32 v138, s69, v204
  v_pk_mul_lo_u16 v136, v136, v205
  v_pk_mul_lo_u16 v137, v137, v205
  s_add_u32 s69, s69, 2048
  v_and_b32 v136, 0xfff0fff0, v136
  s_cmp_eq_u32 s69, 26624
  v_and_b32 v137, 0xfff0fff0, v137
  s_cselect_b32 s69, 0, s69
  ds_write_b64 v138, v[136:137]
  s_add_u32 s65, s65, 4
  s_and_b32 s65, s65, 63
  s_mul_i32 m0, s65, 1040
  s_lshl_b32 s60, s65, 12
  buffer_load_dwordx4 v200, s[28:31], s60 offen lds
  s_waitcnt vmcnt(14)
  v_perm_b32 v140, v141, v140, v206
  v_perm_b32 v141, v143, v142, v206
  v_add_u32 v142, s69, v204
  v_pk_mul_lo_u16 v140, v140, v205
  v_pk_mul_lo_u16 v141, v141, v205
  s_add_u32 s69, s69, 2048
  v_and_b32 v140, 0xfff0fff0, v140
  s_cmp_eq_u32 s69, 26624
  v_and_b32 v141, 0xfff0fff0, v141
  s_cselect_b32 s69, 0, s69
  ds_write_b64 v142, v[140:141]
  s_add_u32 s65, s65, 4
  s_and_b32 s65, s65, 63
  s_mul_i32 m0, s65, 1040
  s_lshl_b32 s60, s65, 12
  buffer_load_dwordx4 v200, s[28:31], s60 offen lds
  s_waitcnt vmcnt(14)
  v_perm_b32 v144, v145, v144, v206
  v_perm_b32 v145, v147, v146, v206
  v_add_u32 v146, s69, v204
  v_pk_mul_lo_u16 v144, v144, v205
  v_pk_mul_lo_u16 v145, v145, v205
  s_add_u32 s69, s69, 2048
  v_and_b32 v144, 0xfff0fff0, v144
  s_cmp_eq_u32 s69, 26624
  v_and_b32 v145, 0xfff0fff0, v145
  s_cselect_b32 s69, 0, s69
  ds_write_b64 v146, v[144:145]
  s_add_u32 s65, s65, 4
  s_and_b32 s65, s65, 63
  s_mul_i32 m0, s65, 1040
  s_lshl_b32 s60, s65, 12
  buffer_load_dwordx4 v200, s[28:31], s60 offen lds
  s_waitcnt vmcnt(14)
  v_perm_b32 v148, v149, v148, v206
  v_perm_b32 v149, v151, v150, v206
  v_add_u32 v150, s69, v204
  v_pk_mul_lo_u16 v148, v148, v205
  v_pk_mul_lo_u16 v149, v149, v205
  s_add_u32 s69, s69, 2048
  v_and_b32 v148, 0xfff0fff0, v148
  s_cmp_eq_u32 s69, 26624
  v_and_b32 v149, 0xfff0fff0, v149
  s_cselect_b32 s69, 0, s69
  ds_write_b64 v150, v[148:149]
  s_add_u32 s65, s65, 4
  s_and_b32 s65, s65, 63
  s_mul_i32 m0, s65, 1040
  s_lshl_b32 s60, s65, 12
  buffer_load_dwordx4 v200, s[28:31], s60 offen lds
  s_waitcnt vmcnt(14)
  v_perm_b32 v152, v153, v152, v206
  v_perm_b32 v153, v155, v154, v206
  v_add_u32 v154, s69, v204
  v_pk_mul_lo_u16 v152, v152, v205
  v_pk_mul_lo_u16 v153, v153, v205
  s_add_u32 s69, s69, 2048
  v_and_b32 v152, 0xfff0fff0, v152
  s_cmp_eq_u32 s69, 26624
  v_and_b32 v153, 0xfff0fff0, v153
  s_cselect_b32 s69, 0, s69
  ds_write_b64 v154, v[152:153]
  s_add_u32 s65, s65, 4
  s_and_b32 s65, s65, 63
  s_mul_i32 m0, s65, 1040
  s_lshl_b32 s60, s65, 12
  buffer_load_dwordx4 v200, s[28:31], s60 offen lds
  s_waitcnt vmcnt(14)
  v_perm_b32 v156, v157, v156, v206
  v_perm_b32 v157, v159, v158, v206
  v_add_u32 v158, s69, v204
  v_pk_mul_lo_u16 v156, v156, v205
  v_pk_mul_lo_u16 v157, v157, v205
  s_add_u32 s69, s69, 2048
  v_and_b32 v156, 0xfff0fff0, v156
  s_cmp_eq_u32 s69, 26624
  v_and_b32 v157, 0xfff0fff0, v157
  s_cselect_b32 s69, 0, s69
  ds_write_b64 v158, v[156:157]
  s_add_u32 s65, s65, 4
  s_and_b32 s65, s65, 63
  s_mul_i32 m0, s65, 1040
  s_lshl_b32 s60, s65, 12
  buffer_load_dwordx4 v200, s[28:31], s60 offen lds
  s_waitcnt vmcnt(14)
  v_perm_b32 v160, v161, v160, v206
  v_perm_b32 v161, v163, v162, v206
  v_add_u32 v162, s69, v204
  v_pk_mul_lo_u16 v160, v160, v205
  v_pk_mul_lo_u16 v161, v161, v205
  s_add_u32 s69, s69, 2048
  v_and_b32 v160, 0xfff0fff0, v160
  s_cmp_eq_u32 s69, 26624
  v_and_b32 v161, 0xfff0fff0, v161
  s_cselect_b32 s69, 0, s69
  ds_write_b64 v162, v[160:161]
  s_add_u32 s65, s65, 4
  s_and_b32 s65, s65, 63
  s_mul_i32 m0, s65, 1040
  s_lshl_b32 s60, s65, 12
  buffer_load_dwordx4 v200, s[28:31], s60 offen lds
  s_waitcnt vmcnt(14)
  v_perm_b32 v164, v165, v164, v206
  v_perm_b32 v165, v167, v166, v206
  v_add_u32 v166, s69, v204
  v_pk_mul_lo_u16 v164, v164, v205
  v_pk_mul_lo_u16 v165, v165, v205
  s_add_u32 s69, s69, 2048
  v_and_b32 v164, 0xfff0fff0, v164
  s_cmp_eq_u32 s69, 26624
  v_and_b32 v165, 0xfff0fff0, v165
  s_cselect_b32 s69, 0, s69
  ds_write_b64 v166, v[164:165]
  s_add_u32 s65, s65, 4
  s_and_b32 s65, s65, 63
  s_mul_i32 m0, s65, 1040
  s_lshl_b32 s60, s65, 12
  buffer_load_dwordx4 v200, s[28:31], s60 offen lds
  s_waitcnt vmcnt(14)
  v_perm_b32 v168, v169, v168, v206
  v_perm_b32 v169, v171, v170, v206
  v_add_u32 v170, s69, v204
  v_pk_mul_lo_u16 v168, v168, v205
  v_pk_mul_lo_u16 v169, v169, v205
  s_add_u32 s69, s69, 2048
  v_and_b32 v168, 0xfff0fff0, v168
  s_cmp_eq_u32 s69, 26624
  v_and_b32 v169, 0xfff0fff0, v169
  s_cselect_b32 s69, 0, s69
  ds_write_b64 v170, v[168:169]
  s_add_u32 s65, s65, 4
  s_and_b32 s65, s65, 63
  s_mul_i32 m0, s65, 1040
  s_lshl_b32 s60, s65, 12
  buffer_load_dwordx4 v200, s[28:31], s60 offen lds
  s_waitcnt vmcnt(14)
  v_perm_b32 v172, v173, v172, v206
  v_perm_b32 v173, v175, v174, v206
  v_add_u32 v174, s69, v204
  v_pk_mul_lo_u16 v172, v172, v205
  v_pk_mul_lo_u16 v173, v173, v205
  s_add_u32 s69, s69, 2048
  v_and_b32 v172, 0xfff0fff0, v172
  s_cmp_eq_u32 s69, 26624
  v_and_b32 v173, 0xfff0fff0, v173
  s_cselect_b32 s69, 0, s69
  ds_write_b64 v174, v[172:173]
  s_add_u32 s65, s65, 4
  s_and_b32 s65, s65, 63
  s_mul_i32 m0, s65, 1040
  s_lshl_b32 s60, s65, 12
  buffer_load_dwordx4 v200, s[28:31], s60 offen lds
  s_waitcnt vmcnt(14)
  v_perm_b32 v176, v177, v176, v206
  v_perm_b32 v177, v179, v178, v206
  v_add_u32 v178, s69, v204
  v_pk_mul_lo_u16 v176, v176, v205
  v_pk_mul_lo_u16 v177, v177, v205
  s_add_u32 s69, s69, 2048
  v_and_b32 v176, 0xfff0fff0, v176
  s_cmp_eq_u32 s69, 26624
  v_and_b32 v177, 0xfff0fff0, v177
  s_cselect_b32 s69, 0, s69
  ds_write_b64 v178, v[176:177]
  s_add_u32 s65, s65, 4
  s_and_b32 s65, s65, 63
  s_mul_i32 m0, s65, 1040
  s_lshl_b32 s60, s65, 12
  buffer_load_dwordx4 v200, s[28:31], s60 offen lds
  buffer_load_dwordx4 v[64:67], v2, s[36:39], s53 offen
  buffer_load_dwordx4 v[68:71], v2, s[36:39], s53 offen offset:2048
  buffer_load_dwordx4 v[72:75], v3, s[36:39], s53 offen
  buffer_load_dwordx4 v[76:79], v3, s[36:39], s53 offen offset:2048
  buffer_load_dwordx4 v[80:83], v2, s[36:39], s50 offen
  buffer_load_dwordx4 v[84:87], v2, s[36:39], s50 offen offset:2048
  buffer_load_dwordx4 v[88:91], v3, s[36:39], s50 offen
  buffer_load_dwordx4 v[92:95], v3, s[36:39], s50 offen offset:2048
  s_add_u32 s53, s53, 2097152
  s_add_u32 s50, s50, 2097152
  s_waitcnt lgkmcnt(0)
  s_add_u32 s3, s3, 0x9E3779B8
  s_or_b32 s3, s3, 1
  v_mov_b32 v12, s3
  s_barrier
  ds_read_b32 v224, v248 offset:0
  ds_read_b32 v225, v248 offset:3200
  ds_read_b32 v226, v249 offset:0
  ds_read_b32 v227, v249 offset:3200
  ds_read_b32 v228, v250 offset:0
  ds_read_b32 v229, v250 offset:3200
  ds_read_b32 v230, v251 offset:0
  ds_read_b32 v231, v251 offset:3200
  s_waitcnt lgkmcnt(0)
  v_add_u32_sdwa v232, v224, v5 dst_sel:DWORD dst_unused:UNUSED_PAD src0_sel:WORD_0 src1_sel:DWORD
  v_add_u32_sdwa v233, v225, v5 dst_sel:DWORD dst_unused:UNUSED_PAD src0_sel:WORD_0 src1_sel:DWORD
  v_add_u32_sdwa v234, v226, v5 dst_sel:DWORD dst_unused:UNUSED_PAD src0_sel:WORD_0 src1_sel:DWORD
  v_add_u32_sdwa v235, v227, v5 dst_sel:DWORD dst_unused:UNUSED_PAD src0_sel:WORD_0 src1_sel:DWORD
  v_add_u32_sdwa v236, v228, v5 dst_sel:DWORD dst_unused:UNUSED_PAD src0_sel:WORD_0 src1_sel:DWORD
  v_add_u32_sdwa v237, v229, v5 dst_sel:DWORD dst_unused:UNUSED_PAD src0_sel:WORD_0 src1_sel:DWORD
  v_add_u32_sdwa v238, v230, v5 dst_sel:DWORD dst_unused:UNUSED_PAD src0_sel:WORD_0 src1_sel:DWORD
  v_add_u32_sdwa v239, v231, v5 dst_sel:DWORD dst_unused:UNUSED_PAD src0_sel:WORD_0 src1_sel:DWORD
  buffer_load_dwordx4 v[96:99], v2, s[36:39], s51 offen
  buffer_load_dwordx4 v[100:103], v2, s[36:39], s51 offen offset:2048
  buffer_load_dwordx4 v[104:107], v3, s[36:39], s51 offen
  buffer_load_dwordx4 v[108:111], v3, s[36:39], s51 offen offset:2048
  buffer_load_dwordx4 v[112:115], v2, s[36:39], s52 offen
  buffer_load_dwordx4 v[116:119], v2, s[36:39], s52 offen offset:2048
  buffer_load_dwordx4 v[120:123], v3, s[36:39], s52 offen
  buffer_load_dwordx4 v[124:127], v3, s[36:39], s52 offen offset:2048
  s_waitcnt vmcnt(16)
  buffer_load_dword v9, v203, s[36:39], 0 offen
  s_barrier
  ds_read_b128 a[32:35], v232
  ds_read_b128 a[36:39], v233
  ds_read_b128 a[40:43], v234
  ds_read_b128 a[44:47], v235
  ds_read_b128 a[48:51], v236
  ds_read_b128 a[52:55], v237
  ds_read_b128 a[56:59], v238
  ds_read_b128 a[60:63], v239
  s_waitcnt vmcnt(16)
Lsh0:
Lst0:
  s_cbranch_execz Lst1
  v_mov_b32_dpp v28, v64 row_ror:8 row_mask:0xf bank_mask:0xf
  v_mov_b32_dpp v29, v65 row_ror:8 row_mask:0xf bank_mask:0xf
  v_mov_b32_dpp v30, v66 row_ror:8 row_mask:0xf bank_mask:0xf
  v_mov_b32_dpp v31, v67 row_ror:8 row_mask:0xf bank_mask:0xf
  v_perm_b32 v128, v28, v64, v4
  v_perm_b32 v132, v29, v65, v4
  v_perm_b32 v136, v30, v66, v4
  v_perm_b32 v140, v31, v67, v4
  s_waitcnt vmcnt(15)
  v_mov_b32_dpp v28, v68 row_ror:8 row_mask:0xf bank_mask:0xf
  v_mov_b32_dpp v29, v69 row_ror:8 row_mask:0xf bank_mask:0xf
  v_mov_b32_dpp v30, v70 row_ror:8 row_mask:0xf bank_mask:0xf
  v_mov_b32_dpp v31, v71 row_ror:8 row_mask:0xf bank_mask:0xf
  v_perm_b32 v129, v28, v68, v4
  v_perm_b32 v133, v29, v69, v4
  v_perm_b32 v137, v30, v70, v4
  v_perm_b32 v141, v31, v71, v4
  s_waitcnt vmcnt(14)
  v_mov_b32_dpp v28, v72 row_ror:8 row_mask:0xf bank_mask:0xf
  v_mov_b32_dpp v29, v73 row_ror:8 row_mask:0xf bank_mask:0xf
  v_mov_b32_dpp v30, v74 row_ror:8 row_mask:0xf bank_mask:0xf
  v_mov_b32_dpp v31, v75 row_ror:8 row_mask:0xf bank_mask:0xf
  v_perm_b32 v130, v28, v72, v4
  v_perm_b32 v134, v29, v73, v4
  v_perm_b32 v138, v30, v74, v4
  v_perm_b32 v142, v31, v75, v4
  s_waitcnt vmcnt(13)
  v_mov_b32_dpp v28, v76 row_ror:8 row_mask:0xf bank_mask:0xf
  v_mov_b32_dpp v29, v77 row_ror:8 row_mask:0xf bank_mask:0xf
  v_mov_b32_dpp v30, v78 row_ror:8 row_mask:0xf bank_mask:0xf
  v_mov_b32_dpp v31, v79 row_ror:8 row_mask:0xf bank_mask:0xf
  v_perm_b32 v131, v28, v76, v4
  v_perm_b32 v135, v29, v77, v4
  v_perm_b32 v139, v30, v78, v4
  v_perm_b32 v143, v31, v79, v4
  buffer_load_dword v9, v202, s[28:31], 0 offen
  buffer_load_dword v24, v26, s[24:27], s55 offen
  s_add_u32 s51, s51, 2097152
  s_add_u32 s52, s52, 2097152
  s_waitcnt vmcnt(13) lgkmcnt(6)
  v_mfma_f32_16x16x32_bf16 v[32:35], a[32:35], v[128:131], 0
  v_mov_b32_dpp v28, v80 row_ror:8 row_mask:0xf bank_mask:0xf
  v_mov_b32_dpp v29, v81 row_ror:8 row_mask:0xf bank_mask:0xf
  v_mfma_f32_16x16x32_bf16 v[36:39], a[32:35], v[132:135], 0
  v_mov_b32_dpp v30, v84 row_ror:8 row_mask:0xf bank_mask:0xf
  v_mov_b32_dpp v31, v82 row_ror:8 row_mask:0xf bank_mask:0xf
  v_mfma_f32_16x16x32_bf16 v[40:43], a[32:35], v[136:139], 0
  buffer_load_dwordx4 v[64:67], v2, s[36:39], s53 offen
  v_mfma_f32_16x16x32_bf16 v[44:47], a[32:35], v[140:143], 0
  ds_read_b128 a[32:35], v232 offset:32
  v_perm_b32 v16, v28, v80, v4
  v_mfma_f32_16x16x32_bf16 v[60:63], a[36:39], v[140:143], 0
  s_add_u32 s6, s44, 96
  v_perm_b32 v80, v29, v81, v4
  v_perm_b32 v17, v30, v84, v4
  v_mfma_f32_16x16x32_bf16 v[56:59], a[36:39], v[136:139], 0
  s_lshl_b32 s6, s6, 2
  v_perm_b32 v84, v31, v82, v4
  v_sub_u32 v241, v248, v252
  v_mfma_f32_16x16x32_bf16 v[52:55], a[36:39], v[132:135], 0
  s_add_u32 s6, s6, s47
  buffer_load_dwordx4 v[68:71], v2, s[36:39], s53 offen offset:2048
  v_mfma_f32_16x16x32_bf16 v[48:51], a[36:39], v[128:131], 0
  s_waitcnt vmcnt(14) lgkmcnt(5)
  ds_read_b128 a[36:39], v233 offset:32
  v_sub_u32 v243, v249, v252
  v_mfma_f32_16x16x32_bf16 v[160:163], a[40:43], v[128:131], 0
  s_lshl_b32 s6, s6, 8
  v_mov_b32_dpp v28, v85 row_ror:8 row_mask:0xf bank_mask:0xf
  v_mov_b32_dpp v29, v86 row_ror:8 row_mask:0xf bank_mask:0xf
  v_mfma_f32_16x16x32_bf16 v[164:167], a[40:43], v[132:135], 0
  s_add_u32 s6, s6, s48
  v_mov_b32_dpp v30, v88 row_ror:8 row_mask:0xf bank_mask:0xf
  v_mov_b32_dpp v31, v83 row_ror:8 row_mask:0xf bank_mask:0xf
  v_mfma_f32_16x16x32_bf16 v[168:171], a[40:43], v[136:139], 0
  s_lshl_b32 s6, s6, 7
  buffer_load_dwordx4 v[72:75], v3, s[36:39], s53 offen
  v_mfma_f32_16x16x32_bf16 v[172:175], a[40:43], v[140:143], 0
  s_add_u32 s7, s6, 4096
  ds_read_b128 a[40:43], v234 offset:32
  v_perm_b32 v81, v28, v85, v4
  v_mfma_f32_16x16x32_bf16 v[188:191], a[44:47], v[140:143], 0
  s_lshl_b32 s68, s49, 2
  v_perm_b32 v85, v29, v86, v4
  v_perm_b32 v18, v30, v88, v4
  v_mfma_f32_16x16x32_bf16 v[184:187], a[44:47], v[136:139], 0
  s_add_u32 s68, s68, s44
  v_perm_b32 v88, v31, v83, v4
  v_sub_u32 v245, v250, v252
  v_mfma_f32_16x16x32_bf16 v[180:183], a[44:47], v[132:135], 0
  s_lshl_b32 s68, s68, 17
  buffer_load_dwordx4 v[76:79], v3, s[36:39], s53 offen offset:2048
  v_mfma_f32_16x16x32_bf16 v[176:179], a[44:47], v[128:131], 0
  s_waitcnt lgkmcnt(5)
  ds_read_b128 a[44:47], v235 offset:32
  v_sub_u32 v247, v251, v252
  v_mfma_f32_16x16x32_bf16 v[192:195], a[48:51], v[128:131], 0
  s_add_u32 s53, s53, 2097152
  v_mov_b32_dpp v28, v89 row_ror:8 row_mask:0xf bank_mask:0xf
  v_mov_b32_dpp v29, v87 row_ror:8 row_mask:0xf bank_mask:0xf
  v_mfma_f32_16x16x32_bf16 v[196:199], a[48:51], v[132:135], 0
  s_lshl_b32 s59, s47, 12
  v_mov_b32_dpp v30, v90 row_ror:8 row_mask:0xf bank_mask:0xf
  v_mov_b32_dpp v31, v91 row_ror:8 row_mask:0xf bank_mask:0xf
  v_mfma_f32_16x16x32_bf16 v[200:203], a[48:51], v[136:139], 0
  s_add_u32 s68, s68, s59
  buffer_load_dwordx4 v[144:147], v2, s[36:39], s50 offen
  v_mfma_f32_16x16x32_bf16 v[204:207], a[48:51], v[140:143], 0
  s_lshl_b32 s59, s48, 7
  ds_read_b128 a[48:51], v236 offset:32
  v_perm_b32 v82, v28, v89, v4
  v_mfma_f32_16x16x32_bf16 v[220:223], a[52:55], v[140:143], 0
  s_add_u32 s68, s68, s59
  v_perm_b32 v89, v29, v87, v4
  v_perm_b32 v86, v30, v90, v4
  v_mfma_f32_16x16x32_bf16 v[216:219], a[52:55], v[136:139], 0
  s_add_u32 s61, s68, 65536
  v_perm_b32 v90, v31, v91, v4
  v_mfma_f32_16x16x32_bf16 v[212:215], a[52:55], v[132:135], 0
  s_add_u32 s65, s64, 4096
  buffer_load_dwordx4 v[148:151], v2, s[36:39], s50 offen offset:2048
  v_mfma_f32_16x16x32_bf16 v[208:211], a[52:55], v[128:131], 0
  s_waitcnt vmcnt(17) lgkmcnt(5)
  ds_read_b128 a[52:55], v237 offset:32
  v_add_u32_sdwa v237, v229, v5 dst_sel:DWORD dst_unused:UNUSED_PAD src0_sel:WORD_1 src1_sel:DWORD
  v_mfma_f32_16x16x32_bf16 a[0:3], a[56:59], v[128:131], 0
  s_mov_b64 s[96:97], s[0:1]
  v_mov_b32_dpp v28, v92 row_ror:8 row_mask:0xf bank_mask:0xf
  v_mov_b32_dpp v29, v93 row_ror:8 row_mask:0xf bank_mask:0xf
  v_mfma_f32_16x16x32_bf16 a[4:7], a[56:59], v[132:135], 0
  s_mov_b32 s99, 0x20000
  v_mov_b32_dpp v30, v94 row_ror:8 row_mask:0xf bank_mask:0xf
  v_mov_b32_dpp v31, v95 row_ror:8 row_mask:0xf bank_mask:0xf
  v_mfma_f32_16x16x32_bf16 a[8:11], a[56:59], v[136:139], 0
  s_or_b32 s98, s2, s44
  s_cselect_b32 s98, 0, 128
  buffer_load_dwordx4 v[152:155], v3, s[36:39], s50 offen
  v_mfma_f32_16x16x32_bf16 a[12:15], a[56:59], v[140:143], 0
  s_add_u32 s66, s64, 8192
  ds_read_b128 a[56:59], v238 offset:32
  v_perm_b32 v19, v28, v92, v4
  v_mfma_f32_16x16x32_bf16 a[28:31], a[60:63], v[140:143], 0
  s_add_u32 s67, s64, 12288
  v_perm_b32 v83, v29, v93, v4
  v_perm_b32 v87, v30, v94, v4
  v_mfma_f32_16x16x32_bf16 a[24:27], a[60:63], v[136:139], 0
  s_mov_b32 s69, 0x10000
  v_perm_b32 v91, v31, v95, v4
  v_add_u32_sdwa v238, v230, v5 dst_sel:DWORD dst_unused:UNUSED_PAD src0_sel:WORD_1 src1_sel:DWORD
  v_mfma_f32_16x16x32_bf16 a[20:23], a[60:63], v[132:135], 0
  buffer_load_dwordx4 v[156:159], v3, s[36:39], s50 offen offset:2048
  v_mfma_f32_16x16x32_bf16 a[16:19], a[60:63], v[128:131], 0
  s_waitcnt vmcnt(17) lgkmcnt(5)
  ds_read_b128 a[60:63], v238
  v_mfma_f32_16x16x32_bf16 v[32:35], a[32:35], v[16:19], v[32:35]
  s_add_u32 s50, s50, 2097152
  v_mov_b32_dpp v28, v96 row_ror:8 row_mask:0xf bank_mask:0xf
  v_mov_b32_dpp v29, v97 row_ror:8 row_mask:0xf bank_mask:0xf
  v_mfma_f32_16x16x32_bf16 v[36:39], a[32:35], v[80:83], v[36:39]
  v_mov_b32_dpp v30, v100 row_ror:8 row_mask:0xf bank_mask:0xf
  v_mov_b32_dpp v31, v98 row_ror:8 row_mask:0xf bank_mask:0xf
  v_mfma_f32_16x16x32_bf16 v[40:43], a[32:35], v[84:87], v[40:43]
  buffer_load_dword v9, v6, s[36:39], s54 offen
  v_mfma_f32_16x16x32_bf16 v[44:47], a[32:35], v[88:91], v[44:47]
  s_add_u32 s54, s54, 2097152
  ds_read_b128 a[32:35], v239 offset:32
  v_perm_b32 v92, v28, v96, v4
  v_mfma_f32_16x16x32_bf16 v[60:63], a[36:39], v[88:91], v[60:63]
  v_perm_b32 v96, v29, v97, v4
  v_perm_b32 v93, v30, v100, v4
  v_mfma_f32_16x16x32_bf16 v[56:59], a[36:39], v[84:87], v[56:59]
  v_mov_b32_dpp v28, v101 row_ror:8 row_mask:0xf bank_mask:0xf
  v_perm_b32 v100, v31, v98, v4
  v_mfma_f32_16x16x32_bf16 v[52:55], a[36:39], v[80:83], v[52:55]
  buffer_load_dwordx4 v[140:143], v2, s[36:39], s51 offen
  v_add_u32_sdwa v239, v231, v5 dst_sel:DWORD dst_unused:UNUSED_PAD src0_sel:WORD_1 src1_sel:DWORD
  v_mfma_f32_16x16x32_bf16 v[48:51], a[36:39], v[16:19], v[48:51]
  s_waitcnt vmcnt(18) lgkmcnt(5)
  ds_read_b128 a[36:39], v239
  v_perm_b32 v97, v28, v101, v4
  v_mfma_f32_16x16x32_bf16 v[160:163], a[40:43], v[16:19], v[160:163]
  s_waitcnt vmcnt(10)
  v_mov_b32_dpp v28, v102 row_ror:8 row_mask:0xf bank_mask:0xf
  v_mov_b32_dpp v29, v104 row_ror:8 row_mask:0xf bank_mask:0xf
  v_mfma_f32_16x16x32_bf16 v[164:167], a[40:43], v[80:83], v[164:167]
  v_mov_b32_dpp v30, v99 row_ror:8 row_mask:0xf bank_mask:0xf
  v_mov_b32_dpp v31, v105 row_ror:8 row_mask:0xf bank_mask:0xf
  v_mfma_f32_16x16x32_bf16 v[168:171], a[40:43], v[84:87], v[168:171]
  ds_read_b32 v229, v250 offset:3232
  v_add_u32_sdwa v236, v228, v5 dst_sel:DWORD dst_unused:UNUSED_PAD src0_sel:WORD_1 src1_sel:DWORD
  v_mfma_f32_16x16x32_bf16 v[172:175], a[40:43], v[88:91], v[172:175]
  ds_read_b128 a[40:43], v236
  v_perm_b32 v101, v28, v102, v4
  v_mfma_f32_16x16x32_bf16 v[188:191], a[44:47], v[88:91], v[188:191]
  v_perm_b32 v94, v29, v104, v4
  v_perm_b32 v104, v30, v99, v4
  v_mfma_f32_16x16x32_bf16 v[184:187], a[44:47], v[84:87], v[184:187]
  v_mov_b32_dpp v28, v103 row_ror:8 row_mask:0xf bank_mask:0xf
  v_perm_b32 v98, v31, v105, v4
  v_mfma_f32_16x16x32_bf16 v[180:183], a[44:47], v[80:83], v[180:183]
  buffer_load_dwordx4 v[136:139], v2, s[36:39], s51 offen offset:2048
  v_mfma_f32_16x16x32_bf16 v[176:179], a[44:47], v[16:19], v[176:179]
  s_waitcnt lgkmcnt(6)
  ds_read_b128 a[44:47], v237
  v_perm_b32 v105, v28, v103, v4
  v_mfma_f32_16x16x32_bf16 v[192:195], a[48:51], v[16:19], v[192:195]
  v_mov_b32_dpp v28, v106 row_ror:8 row_mask:0xf bank_mask:0xf
  v_mov_b32_dpp v29, v107 row_ror:8 row_mask:0xf bank_mask:0xf
  v_mfma_f32_16x16x32_bf16 v[196:199], a[48:51], v[80:83], v[196:199]
  v_mov_b32_dpp v30, v108 row_ror:8 row_mask:0xf bank_mask:0xf
  v_mov_b32_dpp v31, v109 row_ror:8 row_mask:0xf bank_mask:0xf
  v_mfma_f32_16x16x32_bf16 v[200:203], a[48:51], v[84:87], v[200:203]
  ds_read_b32 v228, v250 offset:32
  v_add_u32_sdwa v232, v224, v5 dst_sel:DWORD dst_unused:UNUSED_PAD src0_sel:WORD_1 src1_sel:DWORD
  v_mfma_f32_16x16x32_bf16 v[204:207], a[48:51], v[88:91], v[204:207]
  ds_read_b128 a[48:51], v232
  v_perm_b32 v102, v28, v106, v4
  v_mfma_f32_16x16x32_bf16 v[220:223], a[52:55], v[88:91], v[220:223]
  v_perm_b32 v106, v29, v107, v4
  v_perm_b32 v95, v30, v108, v4
  v_mfma_f32_16x16x32_bf16 v[216:219], a[52:55], v[84:87], v[216:219]
  v_mov_b32_dpp v28, v110 row_ror:8 row_mask:0xf bank_mask:0xf
  v_perm_b32 v99, v31, v109, v4
  v_mfma_f32_16x16x32_bf16 v[212:215], a[52:55], v[80:83], v[212:215]
  buffer_load_dwordx4 v[132:135], v3, s[36:39], s51 offen
  v_mfma_f32_16x16x32_bf16 v[208:211], a[52:55], v[16:19], v[208:211]
  s_waitcnt lgkmcnt(7)
  ds_read_b128 a[52:55], v232 offset:32
  v_perm_b32 v103, v28, v110, v4
  v_mfma_f32_16x16x32_bf16 a[0:3], a[56:59], v[16:19], a[0:3]
  v_mov_b32_dpp v28, v111 row_ror:8 row_mask:0xf bank_mask:0xf
  v_mov_b32_dpp v29, v112 row_ror:8 row_mask:0xf bank_mask:0xf
  v_mfma_f32_16x16x32_bf16 a[0:3], a[60:63], v[92:95], a[0:3]
  v_mov_b32_dpp v30, v113 row_ror:8 row_mask:0xf bank_mask:0xf
  v_mov_b32_dpp v31, v116 row_ror:8 row_mask:0xf bank_mask:0xf
  v_mfma_f32_16x16x32_bf16 a[4:7], a[60:63], v[96:99], a[4:7]
  buffer_store_dwordx4 v[12:15], v8, s[96:99], 0 offen sc1
  v_mfma_f32_16x16x32_bf16 a[4:7], a[56:59], v[80:83], a[4:7]
  v_perm_b32 v107, v28, v111, v4
  v_add_u32_sdwa v233, v225, v5 dst_sel:DWORD dst_unused:UNUSED_PAD src0_sel:WORD_1 src1_sel:DWORD
  v_mfma_f32_16x16x32_bf16 a[8:11], a[56:59], v[84:87], a[8:11]
  v_perm_b32 v108, v29, v112, v4
  v_perm_b32 v112, v30, v113, v4
  v_mfma_f32_16x16x32_bf16 a[8:11], a[60:63], v[100:103], a[8:11]
  v_mov_b32_dpp v28, v114 row_ror:8 row_mask:0xf bank_mask:0xf
  v_perm_b32 v109, v31, v116, v4
  v_mfma_f32_16x16x32_bf16 a[12:15], a[60:63], v[104:107], a[12:15]
  buffer_load_dwordx4 v[128:131], v3, s[36:39], s51 offen offset:2048
  v_mfma_f32_16x16x32_bf16 a[12:15], a[56:59], v[88:91], a[12:15]
  s_waitcnt lgkmcnt(6)
  ds_read_b128 a[60:63], v233
  v_perm_b32 v116, v28, v114, v4
  v_mfma_f32_16x16x32_bf16 a[28:31], a[32:35], v[88:91], a[28:31]
  s_add_u32 s51, s51, 2097152
  v_mov_b32_dpp v28, v117 row_ror:8 row_mask:0xf bank_mask:0xf
  v_mov_b32_dpp v29, v118 row_ror:8 row_mask:0xf bank_mask:0xf
  v_mfma_f32_16x16x32_bf16 a[28:31], a[36:39], v[104:107], a[28:31]
  v_mov_b32_dpp v30, v120 row_ror:8 row_mask:0xf bank_mask:0xf
  v_mov_b32_dpp v31, v115 row_ror:8 row_mask:0xf bank_mask:0xf
  v_mfma_f32_16x16x32_bf16 a[24:27], a[36:39], v[100:103], a[24:27]
  ds_read_b32 v230, v251 offset:32
  v_add_u32_sdwa v234, v226, v5 dst_sel:DWORD dst_unused:UNUSED_PAD src0_sel:WORD_1 src1_sel:DWORD
  v_mfma_f32_16x16x32_bf16 a[24:27], a[32:35], v[84:87], a[24:27]
  ds_read_b128 a[56:59], v233 offset:32
  v_perm_b32 v113, v28, v117, v4
  v_mfma_f32_16x16x32_bf16 a[20:23], a[32:35], v[80:83], a[20:23]
  v_perm_b32 v117, v29, v118, v4
  v_perm_b32 v110, v30, v120, v4
  v_mfma_f32_16x16x32_bf16 a[20:23], a[36:39], v[96:99], a[20:23]
  v_mov_b32_dpp v28, v121 row_ror:8 row_mask:0xf bank_mask:0xf
  v_perm_b32 v120, v31, v115, v4
  v_mfma_f32_16x16x32_bf16 a[16:19], a[36:39], v[92:95], a[16:19]
  buffer_load_dwordx4 v[88:91], v2, s[36:39], s52 offen
  v_mfma_f32_16x16x32_bf16 a[16:19], a[32:35], v[16:19], a[16:19]
  s_waitcnt lgkmcnt(6)
  ds_read_b128 a[36:39], v234
  v_perm_b32 v114, v28, v121, v4
  v_mfma_f32_16x16x32_bf16 v[192:195], a[40:43], v[92:95], v[192:195]
  v_mov_b32_dpp v28, v119 row_ror:8 row_mask:0xf bank_mask:0xf
  v_mov_b32_dpp v29, v122 row_ror:8 row_mask:0xf bank_mask:0xf
  v_mfma_f32_16x16x32_bf16 v[196:199], a[40:43], v[96:99], v[196:199]
  v_mov_b32_dpp v30, v123 row_ror:8 row_mask:0xf bank_mask:0xf
  v_mov_b32_dpp v31, v124 row_ror:8 row_mask:0xf bank_mask:0xf
  v_mfma_f32_16x16x32_bf16 v[200:203], a[40:43], v[100:103], v[200:203]
  ds_read_b32 v231, v251 offset:3232
  v_add_u32_sdwa v235, v227, v5 dst_sel:DWORD dst_unused:UNUSED_PAD src0_sel:WORD_1 src1_sel:DWORD
  v_mfma_f32_16x16x32_bf16 v[204:207], a[40:43], v[104:107], v[204:207]
  ds_read_b128 a[32:35], v234 offset:32
  v_perm_b32 v121, v28, v119, v4
  v_mfma_f32_16x16x32_bf16 v[220:223], a[44:47], v[104:107], v[220:223]
  v_perm_b32 v118, v29, v122, v4
  v_perm_b32 v122, v30, v123, v4
  v_mfma_f32_16x16x32_bf16 v[216:219], a[44:47], v[100:103], v[216:219]
  v_mov_b32_dpp v28, v125 row_ror:8 row_mask:0xf bank_mask:0xf
  v_perm_b32 v111, v31, v124, v4
  v_mfma_f32_16x16x32_bf16 v[212:215], a[44:47], v[96:99], v[212:215]
  buffer_load_dwordx4 v[84:87], v2, s[36:39], s52 offen offset:2048
  v_mfma_f32_16x16x32_bf16 v[208:211], a[44:47], v[92:95], v[208:211]
  s_waitcnt vmcnt(14) lgkmcnt(6)
  ds_read_b128 a[40:43], v235
  v_perm_b32 v115, v28, v125, v4
  v_mfma_f32_16x16x32_bf16 v[32:35], a[48:51], v[92:95], v[32:35]
  v_mov_b32_dpp v28, v126 row_ror:8 row_mask:0xf bank_mask:0xf
  v_mov_b32_dpp v29, v127 row_ror:8 row_mask:0xf bank_mask:0xf
  v_mfma_f32_16x16x32_bf16 v[32:35], a[52:55], v[108:111], v[32:35]
  v_mov_b32_dpp v30, v64 row_ror:8 row_mask:0xf bank_mask:0xf
  v_mov_b32_dpp v31, v65 row_ror:8 row_mask:0xf bank_mask:0xf
  v_mfma_f32_16x16x32_bf16 v[36:39], a[52:55], v[112:115], v[36:39]
  v_lshlrev_b32 v24, 8, v24
  v_mfma_f32_16x16x32_bf16 v[36:39], a[48:51], v[96:99], v[36:39]
  ds_read_b128 a[44:47], v235 offset:32
  v_perm_b32 v119, v28, v126, v4
  v_mfma_f32_16x16x32_bf16 v[40:43], a[48:51], v[100:103], v[40:43]
  v_perm_b32 v123, v29, v127, v4
  v_perm_b32 v124, v30, v64, v4
  v_mfma_f32_16x16x32_bf16 v[40:43], a[52:55], v[116:119], v[40:43]
  v_mov_b32_dpp v28, v68 row_ror:8 row_mask:0xf bank_mask:0xf
  v_perm_b32 v64, v31, v65, v4
  v_mfma_f32_16x16x32_bf16 v[44:47], a[52:55], v[120:123], v[44:47]
  buffer_load_dwordx4 v[80:83], v3, s[36:39], s52 offen
  v_mfma_f32_16x16x32_bf16 v[44:47], a[48:51], v[104:107], v[44:47]
  s_waitcnt vmcnt(14) lgkmcnt(5)
  ds_read_b128 a[52:55], v236 offset:32
  v_perm_b32 v125, v28, v68, v4
  v_mfma_f32_16x16x32_bf16 v[60:63], a[60:63], v[104:107], v[60:63]
  v_mov_b32_dpp v28, v66 row_ror:8 row_mask:0xf bank_mask:0xf
  v_mov_b32_dpp v29, v69 row_ror:8 row_mask:0xf bank_mask:0xf
  v_mfma_f32_16x16x32_bf16 v[60:63], a[56:59], v[120:123], v[60:63]
  v_mov_b32_dpp v30, v70 row_ror:8 row_mask:0xf bank_mask:0xf
  v_mov_b32_dpp v31, v72 row_ror:8 row_mask:0xf bank_mask:0xf
  v_mfma_f32_16x16x32_bf16 v[56:59], a[56:59], v[116:119], v[56:59]
  ds_read_b32 v224, v248 offset:32
  v_add_u32_sdwa v236, v228, v5 dst_sel:DWORD dst_unused:UNUSED_PAD src0_sel:WORD_0 src1_sel:DWORD
  v_mfma_f32_16x16x32_bf16 v[56:59], a[60:63], v[100:103], v[56:59]
  ds_read_b128 a[48:51], v236
  v_perm_b32 v68, v28, v66, v4
  v_mfma_f32_16x16x32_bf16 v[52:55], a[60:63], v[96:99], v[52:55]
  v_perm_b32 v65, v29, v69, v4
  v_perm_b32 v69, v30, v70, v4
  v_mfma_f32_16x16x32_bf16 v[52:55], a[56:59], v[112:115], v[52:55]
  v_mov_b32_dpp v28, v67 row_ror:8 row_mask:0xf bank_mask:0xf
  v_perm_b32 v126, v31, v72, v4
  v_mfma_f32_16x16x32_bf16 v[48:51], a[56:59], v[108:111], v[48:51]
  buffer_load_dwordx4 v[16:19], v3, s[36:39], s52 offen offset:2048
  v_mfma_f32_16x16x32_bf16 v[48:51], a[60:63], v[92:95], v[48:51]
  s_waitcnt lgkmcnt(5)
  ds_read_b128 a[56:59], v237 offset:32
  v_perm_b32 v72, v28, v67, v4
  v_mfma_f32_16x16x32_bf16 v[160:163], a[36:39], v[92:95], v[160:163]
  s_add_u32 s52, s52, 2097152
  v_mov_b32_dpp v28, v73 row_ror:8 row_mask:0xf bank_mask:0xf
  v_mov_b32_dpp v29, v71 row_ror:8 row_mask:0xf bank_mask:0xf
  v_mfma_f32_16x16x32_bf16 v[160:163], a[32:35], v[108:111], v[160:163]
  v_mov_b32_dpp v30, v74 row_ror:8 row_mask:0xf bank_mask:0xf
  v_mov_b32_dpp v31, v75 row_ror:8 row_mask:0xf bank_mask:0xf
  v_mfma_f32_16x16x32_bf16 v[164:167], a[32:35], v[112:115], v[164:167]
  ds_read_b32 v225, v248 offset:3232
  v_add_u32_sdwa v237, v229, v5 dst_sel:DWORD dst_unused:UNUSED_PAD src0_sel:WORD_0 src1_sel:DWORD
  v_mfma_f32_16x16x32_bf16 v[164:167], a[36:39], v[96:99], v[164:167]
  ds_read_b128 a[60:63], v237
  v_perm_b32 v66, v28, v73, v4
  v_mfma_f32_16x16x32_bf16 v[168:171], a[36:39], v[100:103], v[168:171]
  v_perm_b32 v73, v29, v71, v4
  v_perm_b32 v70, v30, v74, v4
  v_mfma_f32_16x16x32_bf16 v[168:171], a[32:35], v[116:119], v[168:171]
  ds_read_b32 v226, v249 offset:32
  v_perm_b32 v74, v31, v75, v4
  v_mfma_f32_16x16x32_bf16 v[172:175], a[32:35], v[120:123], v[172:175]
  v_mfma_f32_16x16x32_bf16 v[172:175], a[36:39], v[104:107], v[172:175]
  s_waitcnt vmcnt(14) lgkmcnt(7)
  ds_read_b128 a[32:35], v238 offset:32
  v_add_u32_sdwa v238, v230, v5 dst_sel:DWORD dst_unused:UNUSED_PAD src0_sel:WORD_0 src1_sel:DWORD
  v_mfma_f32_16x16x32_bf16 v[188:191], a[40:43], v[104:107], v[188:191]
  v_mov_b32_dpp v28, v76 row_ror:8 row_mask:0xf bank_mask:0xf
  v_mov_b32_dpp v29, v77 row_ror:8 row_mask:0xf bank_mask:0xf
  v_mfma_f32_16x16x32_bf16 v[188:191], a[44:47], v[120:123], v[188:191]
  v_mov_b32_dpp v30, v78 row_ror:8 row_mask:0xf bank_mask:0xf
  v_mov_b32_dpp v31, v79 row_ror:8 row_mask:0xf bank_mask:0xf
  v_mfma_f32_16x16x32_bf16 v[184:187], a[44:47], v[116:119], v[184:187]
  buffer_store_dwordx4 a[248:251], v8, s[40:43], s63 offen sc1
  v_mfma_f32_16x16x32_bf16 v[184:187], a[40:43], v[100:103], v[184:187]
  s_xor_b32 s63, s63, 4096
  ds_read_b128 a[36:39], v238
  v_perm_b32 v127, v28, v76, v4
  v_mfma_f32_16x16x32_bf16 v[180:183], a[40:43], v[96:99], v[180:183]
  v_perm_b32 v67, v29, v77, v4
  v_perm_b32 v71, v30, v78, v4
  v_mfma_f32_16x16x32_bf16 v[180:183], a[44:47], v[112:115], v[180:183]
  ds_read_b32 v227, v249 offset:3232
  v_perm_b32 v75, v31, v79, v4
  v_mfma_f32_16x16x32_bf16 v[176:179], a[44:47], v[108:111], v[176:179]
  buffer_load_dwordx4 v[104:107], v2, s[36:39], s53 offen
  v_mfma_f32_16x16x32_bf16 v[176:179], a[40:43], v[92:95], v[176:179]
  s_waitcnt vmcnt(14) lgkmcnt(5)
  ds_read_b128 a[44:47], v239 offset:32
  v_add_u32_sdwa v239, v231, v5 dst_sel:DWORD dst_unused:UNUSED_PAD src0_sel:WORD_0 src1_sel:DWORD
  v_mfma_f32_16x16x32_bf16 v[192:195], a[52:55], v[108:111], v[192:195]
  v_mov_b32_dpp v28, v144 row_ror:8 row_mask:0xf bank_mask:0xf
  v_mov_b32_dpp v29, v145 row_ror:8 row_mask:0xf bank_mask:0xf
  v_mfma_f32_16x16x32_bf16 v[192:195], a[48:51], v[124:127], v[192:195]
  v_mov_b32_dpp v30, v148 row_ror:8 row_mask:0xf bank_mask:0xf
  v_mov_b32_dpp v31, v146 row_ror:8 row_mask:0xf bank_mask:0xf
  v_mfma_f32_16x16x32_bf16 v[196:199], a[48:51], v[64:67], v[196:199]
  ds_read_u16 v240, v241 offset:192
  v_mfma_f32_16x16x32_bf16 v[196:199], a[52:55], v[112:115], v[196:199]
  ds_read_b128 a[40:43], v239
  v_perm_b32 v76, v28, v144, v4
  v_mfma_f32_16x16x32_bf16 v[200:203], a[52:55], v[116:119], v[200:203]
  v_perm_b32 v144, v29, v145, v4
  v_perm_b32 v77, v30, v148, v4
  v_mfma_f32_16x16x32_bf16 v[200:203], a[48:51], v[68:71], v[200:203]
  v_perm_b32 v148, v31, v146, v4
  v_add_u32_sdwa v232, v224, v5 dst_sel:DWORD dst_unused:UNUSED_PAD src0_sel:WORD_0 src1_sel:DWORD
  v_mfma_f32_16x16x32_bf16 v[204:207], a[48:51], v[72:75], v[204:207]
  buffer_load_dwordx4 v[100:103], v2, s[36:39], s53 offen offset:2048
  v_mfma_f32_16x16x32_bf16 v[204:207], a[52:55], v[120:123], v[204:207]
  s_waitcnt vmcnt(14) lgkmcnt(6)
  ds_read_b128 a[48:51], v232
  v_add_u32_sdwa v233, v225, v5 dst_sel:DWORD dst_unused:UNUSED_PAD src0_sel:WORD_0 src1_sel:DWORD
  v_mfma_f32_16x16x32_bf16 v[220:223], a[56:59], v[120:123], v[220:223]
  v_mov_b32_dpp v28, v149 row_ror:8 row_mask:0xf bank_mask:0xf
  v_mov_b32_dpp v29, v150 row_ror:8 row_mask:0xf bank_mask:0xf
  v_mfma_f32_16x16x32_bf16 v[220:223], a[60:63], v[72:75], v[220:223]
  v_mov_b32_dpp v30, v152 row_ror:8 row_mask:0xf bank_mask:0xf
  v_mov_b32_dpp v31, v147 row_ror:8 row_mask:0xf bank_mask:0xf
  v_mfma_f32_16x16x32_bf16 v[216:219], a[60:63], v[68:71], v[216:219]
  ds_read_u16 v241, v241 offset:3392
  v_mfma_f32_16x16x32_bf16 v[216:219], a[56:59], v[116:119], v[216:219]
  ds_read_b128 a[52:55], v232 offset:32
  v_perm_b32 v145, v28, v149, v4
  v_mfma_f32_16x16x32_bf16 v[212:215], a[56:59], v[112:115], v[212:215]
  v_perm_b32 v149, v29, v150, v4
  v_perm_b32 v78, v30, v152, v4
  v_mfma_f32_16x16x32_bf16 v[212:215], a[60:63], v[64:67], v[212:215]
  v_perm_b32 v152, v31, v147, v4
  v_add_u32_dpp v26, v24, v20 row_newbcast:0 row_mask:0xf bank_mask:0xf
  v_mfma_f32_16x16x32_bf16 v[208:211], a[60:63], v[124:127], v[208:211]
  buffer_load_dwordx4 v[96:99], v3, s[36:39], s53 offen
  v_mfma_f32_16x16x32_bf16 v[208:211], a[56:59], v[108:111], v[208:211]
  s_waitcnt lgkmcnt(6)
  ds_read_b128 a[60:63], v233
  v_add_u32_sdwa v234, v226, v5 dst_sel:DWORD dst_unused:UNUSED_PAD src0_sel:WORD_0 src1_sel:DWORD
  v_mfma_f32_16x16x32_bf16 a[0:3], a[32:35], v[108:111], a[0:3]
  v_mov_b32_dpp v28, v153 row_ror:8 row_mask:0xf bank_mask:0xf
  v_mov_b32_dpp v29, v151 row_ror:8 row_mask:0xf bank_mask:0xf
  v_mfma_f32_16x16x32_bf16 a[0:3], a[36:39], v[124:127], a[0:3]
  s_add_u32 m0, s5, 4096
  v_mov_b32_dpp v30, v154 row_ror:8 row_mask:0xf bank_mask:0xf
  v_mov_b32_dpp v31, v155 row_ror:8 row_mask:0xf bank_mask:0xf
  v_mfma_f32_16x16x32_bf16 a[4:7], a[36:39], v[64:67], a[4:7]
  buffer_load_dwordx4 v26, s[28:31], 0 offen lds
  v_mfma_f32_16x16x32_bf16 a[4:7], a[32:35], v[112:115], a[4:7]
  ds_read_b128 a[56:59], v233 offset:32
  v_perm_b32 v146, v28, v153, v4
  v_mfma_f32_16x16x32_bf16 a[8:11], a[32:35], v[116:119], a[8:11]
  v_perm_b32 v153, v29, v151, v4
  v_perm_b32 v150, v30, v154, v4
  v_mfma_f32_16x16x32_bf16 a[8:11], a[36:39], v[68:71], a[8:11]
  v_perm_b32 v154, v31, v155, v4
  v_add_u32_dpp v27, v24, v21 row_newbcast:1 row_mask:0xf bank_mask:0xf
  v_mfma_f32_16x16x32_bf16 a[12:15], a[36:39], v[72:75], a[12:15]
  buffer_load_dwordx4 v[92:95], v3, s[36:39], s53 offen offset:2048
  v_mfma_f32_16x16x32_bf16 a[12:15], a[32:35], v[120:123], a[12:15]
  s_waitcnt vmcnt(16) lgkmcnt(5)
  ds_read_b128 a[36:39], v234
  v_add_u32_sdwa v235, v227, v5 dst_sel:DWORD dst_unused:UNUSED_PAD src0_sel:WORD_0 src1_sel:DWORD
  v_mfma_f32_16x16x32_bf16 a[28:31], a[44:47], v[120:123], a[28:31]
  s_add_u32 s53, s53, 2097152
  v_mov_b32_dpp v28, v156 row_ror:8 row_mask:0xf bank_mask:0xf
  v_mov_b32_dpp v29, v157 row_ror:8 row_mask:0xf bank_mask:0xf
  v_mfma_f32_16x16x32_bf16 a[28:31], a[40:43], v[72:75], a[28:31]
  s_add_u32 m0, s5, 5120
  v_mov_b32_dpp v30, v158 row_ror:8 row_mask:0xf bank_mask:0xf
  v_mov_b32_dpp v31, v159 row_ror:8 row_mask:0xf bank_mask:0xf
  v_mfma_f32_16x16x32_bf16 a[24:27], a[40:43], v[68:71], a[24:27]
  buffer_load_dwordx4 v27, s[28:31], 0 offen lds
  v_mfma_f32_16x16x32_bf16 a[24:27], a[44:47], v[116:119], a[24:27]
  ds_read_b128 a[32:35], v234 offset:32
  v_perm_b32 v79, v28, v156, v4
  v_mfma_f32_16x16x32_bf16 a[20:23], a[44:47], v[112:115], a[20:23]
  v_perm_b32 v147, v29, v157, v4
  v_perm_b32 v151, v30, v158, v4
  v_mfma_f32_16x16x32_bf16 a[20:23], a[40:43], v[64:67], a[20:23]
  ds_read_u16 v242, v243 offset:192
  v_perm_b32 v155, v31, v159, v4
  v_mfma_f32_16x16x32_bf16 a[16:19], a[40:43], v[124:127], a[16:19]
  buffer_load_dwordx4 v[120:123], v2, s[36:39], s50 offen
  v_mfma_f32_16x16x32_bf16 a[16:19], a[44:47], v[108:111], a[16:19]
  s_waitcnt vmcnt(15) lgkmcnt(5)
  ds_read_b128 a[40:43], v235
  v_add_u32_dpp v26, v24, v22 row_newbcast:2 row_mask:0xf bank_mask:0xf
  v_mfma_f32_16x16x32_bf16 v[32:35], a[48:51], v[124:127], v[32:35]
  v_mov_b32_dpp v28, v140 row_ror:8 row_mask:0xf bank_mask:0xf
  v_mov_b32_dpp v29, v141 row_ror:8 row_mask:0xf bank_mask:0xf
  v_mfma_f32_16x16x32_bf16 v[32:35], a[52:55], v[76:79], v[32:35]
  s_add_u32 m0, s5, 6144
  v_mov_b32_dpp v30, v136 row_ror:8 row_mask:0xf bank_mask:0xf
  v_mov_b32_dpp v31, v142 row_ror:8 row_mask:0xf bank_mask:0xf
  v_mfma_f32_16x16x32_bf16 v[36:39], a[52:55], v[144:147], v[36:39]
  buffer_load_dwordx4 v26, s[28:31], 0 offen lds
  v_mfma_f32_16x16x32_bf16 v[36:39], a[48:51], v[64:67], v[36:39]
  ds_read_b128 a[44:47], v235 offset:32
  v_perm_b32 v156, v28, v140, v4
  v_mfma_f32_16x16x32_bf16 v[40:43], a[48:51], v[68:71], v[40:43]
  v_perm_b32 v140, v29, v141, v4
  v_perm_b32 v157, v30, v136, v4
  v_mfma_f32_16x16x32_bf16 v[40:43], a[52:55], v[148:151], v[40:43]
  v_perm_b32 v136, v31, v142, v4
  v_add_u32_dpp v27, v24, v23 row_newbcast:3 row_mask:0xf bank_mask:0xf
  v_mfma_f32_16x16x32_bf16 v[44:47], a[52:55], v[152:155], v[44:47]
  buffer_load_dwordx4 v[116:119], v2, s[36:39], s50 offen offset:2048
  v_mfma_f32_16x16x32_bf16 v[44:47], a[48:51], v[72:75], v[44:47]
  s_waitcnt vmcnt(16) lgkmcnt(5)
  ds_read_b128 a[52:55], v236 offset:32
  v_add_u32_sdwa v236, v228, v5 dst_sel:DWORD dst_unused:UNUSED_PAD src0_sel:WORD_1 src1_sel:DWORD
  v_mfma_f32_16x16x32_bf16 v[60:63], a[60:63], v[72:75], v[60:63]
  v_mov_b32_dpp v28, v137 row_ror:8 row_mask:0xf bank_mask:0xf
  v_mov_b32_dpp v29, v138 row_ror:8 row_mask:0xf bank_mask:0xf
  v_mfma_f32_16x16x32_bf16 v[60:63], a[56:59], v[152:155], v[60:63]
  s_add_u32 m0, s5, 7168
  v_mov_b32_dpp v30, v132 row_ror:8 row_mask:0xf bank_mask:0xf
  v_mov_b32_dpp v31, v143 row_ror:8 row_mask:0xf bank_mask:0xf
  v_mfma_f32_16x16x32_bf16 v[56:59], a[56:59], v[148:151], v[56:59]
  buffer_load_dwordx4 v27, s[28:31], 0 offen lds
  v_mfma_f32_16x16x32_bf16 v[56:59], a[60:63], v[68:71], v[56:59]
  ds_read_b128 a[48:51], v236
  v_perm_b32 v141, v28, v137, v4
  v_mfma_f32_16x16x32_bf16 v[52:55], a[60:63], v[64:67], v[52:55]
  v_perm_b32 v137, v29, v138, v4
  v_perm_b32 v158, v30, v132, v4
  v_mfma_f32_16x16x32_bf16 v[52:55], a[56:59], v[144:147], v[52:55]
  ds_read_b32 v228, v250 offset:64
  v_perm_b32 v132, v31, v143, v4
  v_mfma_f32_16x16x32_bf16 v[48:51], a[56:59], v[76:79], v[48:51]
Lst1:
  s_cbranch_execz Lret
  buffer_load_dwordx4 v[112:115], v3, s[36:39], s50 offen
  v_mfma_f32_16x16x32_bf16 v[48:51], a[60:63], v[124:127], v[48:51]
  s_waitcnt lgkmcnt(6)
  ds_read_b128 a[56:59], v237 offset:32
  v_add_u32_sdwa v237, v229, v5 dst_sel:DWORD dst_unused:UNUSED_PAD src0_sel:WORD_1 src1_sel:DWORD
  v_mfma_f32_16x16x32_bf16 v[160:163], a[36:39], v[124:127], v[160:163]
  v_mov_b32_dpp v28, v133 row_ror:8 row_mask:0xf bank_mask:0xf
  v_mov_b32_dpp v29, v139 row_ror:8 row_mask:0xf bank_mask:0xf
  v_mfma_f32_16x16x32_bf16 v[160:163], a[32:35], v[76:79], v[160:163]
  s_add_u32 m0, s56, 0
  v_mov_b32_dpp v30, v134 row_ror:8 row_mask:0xf bank_mask:0xf
  v_mov_b32_dpp v31, v135 row_ror:8 row_mask:0xf bank_mask:0xf
  v_mfma_f32_16x16x32_bf16 v[164:167], a[32:35], v[144:147], v[164:167]
  s_mov_b32 s4, 0
  buffer_load_dwordx4 v8, s[32:35], s4 offen lds
  v_mfma_f32_16x16x32_bf16 v[164:167], a[36:39], v[64:67], v[164:167]
  ds_read_b128 a[60:63], v237
  v_perm_b32 v142, v28, v133, v4
  v_mfma_f32_16x16x32_bf16 v[168:171], a[36:39], v[68:71], v[168:171]
  v_perm_b32 v133, v29, v139, v4
  v_perm_b32 v138, v30, v134, v4
  v_mfma_f32_16x16x32_bf16 v[168:171], a[32:35], v[148:151], v[168:171]
  ds_read_b32 v229, v250 offset:3264
  v_perm_b32 v134, v31, v135, v4
  v_mfma_f32_16x16x32_bf16 v[172:175], a[32:35], v[152:155], v[172:175]
  buffer_load_dwordx4 v[108:111], v3, s[36:39], s50 offen offset:2048
  v_mfma_f32_16x16x32_bf16 v[172:175], a[36:39], v[72:75], v[172:175]
  s_waitcnt vmcnt(18) lgkmcnt(6)
  ds_read_b128 a[32:35], v238 offset:32
  v_add_u32_sdwa v238, v230, v5 dst_sel:DWORD dst_unused:UNUSED_PAD src0_sel:WORD_1 src1_sel:DWORD
  v_mfma_f32_16x16x32_bf16 v[188:191], a[40:43], v[72:75], v[188:191]
  s_add_u32 s50, s50, 2097152
  v_mov_b32_dpp v28, v128 row_ror:8 row_mask:0xf bank_mask:0xf
  v_mov_b32_dpp v29, v129 row_ror:8 row_mask:0xf bank_mask:0xf
  v_mfma_f32_16x16x32_bf16 v[188:191], a[44:47], v[152:155], v[188:191]
  v_mov_b32_dpp v30, v130 row_ror:8 row_mask:0xf bank_mask:0xf
  v_mov_b32_dpp v31, v131 row_ror:8 row_mask:0xf bank_mask:0xf
  v_mfma_f32_16x16x32_bf16 v[184:187], a[44:47], v[148:151], v[184:187]
  buffer_load_dword v9, v6, s[36:39], s54 offen
  v_mfma_f32_16x16x32_bf16 v[184:187], a[40:43], v[68:71], v[184:187]
  s_add_u32 s54, s54, 2097152
  ds_read_b128 a[36:39], v238
  v_perm_b32 v159, v28, v128, v4
  v_mfma_f32_16x16x32_bf16 v[180:183], a[40:43], v[64:67], v[180:183]
  v_perm_b32 v143, v29, v129, v4
  v_perm_b32 v139, v30, v130, v4
  v_mfma_f32_16x16x32_bf16 v[180:183], a[44:47], v[144:147], v[180:183]
  ds_read_b32 v230, v251 offset:64
  v_perm_b32 v135, v31, v131, v4
  v_mfma_f32_16x16x32_bf16 v[176:179], a[44:47], v[76:79], v[176:179]
  buffer_load_dwordx4 v[72:75], v2, s[36:39], s51 offen
  v_mfma_f32_16x16x32_bf16 v[176:179], a[40:43], v[124:127], v[176:179]
  s_waitcnt vmcnt(18) lgkmcnt(7)
  ds_read_b128 a[44:47], v239 offset:32
  v_add_u32_sdwa v239, v231, v5 dst_sel:DWORD dst_unused:UNUSED_PAD src0_sel:WORD_1 src1_sel:DWORD
  v_mfma_f32_16x16x32_bf16 v[192:195], a[52:55], v[76:79], v[192:195]
  v_mov_b32_dpp v28, v88 row_ror:8 row_mask:0xf bank_mask:0xf
  v_mov_b32_dpp v29, v89 row_ror:8 row_mask:0xf bank_mask:0xf
  v_mfma_f32_16x16x32_bf16 v[192:195], a[48:51], v[156:159], v[192:195]
  v_mov_b32_dpp v30, v84 row_ror:8 row_mask:0xf bank_mask:0xf
  v_mov_b32_dpp v31, v90 row_ror:8 row_mask:0xf bank_mask:0xf
  v_mfma_f32_16x16x32_bf16 v[196:199], a[48:51], v[140:143], v[196:199]
  ds_read_u16 v243, v243 offset:3392
  v_mfma_f32_16x16x32_bf16 v[196:199], a[52:55], v[144:147], v[196:199]
  ds_read_b128 a[40:43], v239
  v_perm_b32 v128, v28, v88, v4
  v_mfma_f32_16x16x32_bf16 v[200:203], a[52:55], v[148:151], v[200:203]
  v_perm_b32 v88, v29, v89, v4
  v_perm_b32 v129, v30, v84, v4
  v_mfma_f32_16x16x32_bf16 v[200:203], a[48:51], v[136:139], v[200:203]
  v_perm_b32 v84, v31, v90, v4
  v_add_u32_sdwa v232, v224, v5 dst_sel:DWORD dst_unused:UNUSED_PAD src0_sel:WORD_1 src1_sel:DWORD
  v_mfma_f32_16x16x32_bf16 v[204:207], a[48:51], v[132:135], v[204:207]
  buffer_load_dwordx4 v[68:71], v2, s[36:39], s51 offen offset:2048
  v_mfma_f32_16x16x32_bf16 v[204:207], a[52:55], v[152:155], v[204:207]
  s_waitcnt vmcnt(18) lgkmcnt(7)
  ds_read_b128 a[48:51], v232
  v_add_u32_sdwa v233, v225, v5 dst_sel:DWORD dst_unused:UNUSED_PAD src0_sel:WORD_1 src1_sel:DWORD
  v_mfma_f32_16x16x32_bf16 v[220:223], a[56:59], v[152:155], v[220:223]
  v_mov_b32_dpp v28, v85 row_ror:8 row_mask:0xf bank_mask:0xf
  v_mov_b32_dpp v29, v86 row_ror:8 row_mask:0xf bank_mask:0xf
  v_mfma_f32_16x16x32_bf16 v[220:223], a[60:63], v[132:135], v[220:223]
  v_mov_b32_dpp v30, v80 row_ror:8 row_mask:0xf bank_mask:0xf
  v_mov_b32_dpp v31, v91 row_ror:8 row_mask:0xf bank_mask:0xf
  v_mfma_f32_16x16x32_bf16 v[216:219], a[60:63], v[136:139], v[216:219]
  buffer_store_dwordx4 a[248:251], v8, s[40:43], s63 offen sc1
  v_mfma_f32_16x16x32_bf16 v[216:219], a[56:59], v[148:151], v[216:219]
  s_xor_b32 s63, s63, 12288
  ds_read_b128 a[52:55], v232 offset:32
  v_perm_b32 v89, v28, v85, v4
  v_mfma_f32_16x16x32_bf16 v[212:215], a[56:59], v[144:147], v[212:215]
  v_perm_b32 v85, v29, v86, v4
  v_perm_b32 v130, v30, v80, v4
  v_mfma_f32_16x16x32_bf16 v[212:215], a[60:63], v[140:143], v[212:215]
  ds_read_b32 v231, v251 offset:3264
  v_perm_b32 v80, v31, v91, v4
  v_mfma_f32_16x16x32_bf16 v[208:211], a[60:63], v[156:159], v[208:211]
  buffer_load_dwordx4 v[64:67], v3, s[36:39], s51 offen
  v_mfma_f32_16x16x32_bf16 v[208:211], a[56:59], v[76:79], v[208:211]
  s_waitcnt lgkmcnt(7)
  ds_read_b128 a[60:63], v233
  v_add_u32_sdwa v234, v226, v5 dst_sel:DWORD dst_unused:UNUSED_PAD src0_sel:WORD_1 src1_sel:DWORD
  v_mfma_f32_16x16x32_bf16 a[0:3], a[32:35], v[76:79], a[0:3]
  v_mov_b32_dpp v28, v81 row_ror:8 row_mask:0xf bank_mask:0xf
  v_mov_b32_dpp v29, v87 row_ror:8 row_mask:0xf bank_mask:0xf
  v_mfma_f32_16x16x32_bf16 a[0:3], a[36:39], v[156:159], a[0:3]
  v_mov_b32_dpp v30, v82 row_ror:8 row_mask:0xf bank_mask:0xf
  v_mov_b32_dpp v31, v83 row_ror:8 row_mask:0xf bank_mask:0xf
  v_mfma_f32_16x16x32_bf16 a[4:7], a[36:39], v[140:143], a[4:7]
  buffer_load_dword v25, v1, s[24:27], s55 offen offset:256
  v_mfma_f32_16x16x32_bf16 a[4:7], a[32:35], v[144:147], a[4:7]
  ds_read_b128 a[56:59], v233 offset:32
  v_perm_b32 v90, v28, v81, v4
  v_mfma_f32_16x16x32_bf16 a[8:11], a[32:35], v[148:151], a[8:11]
  v_perm_b32 v81, v29, v87, v4
  v_perm_b32 v86, v30, v82, v4
  v_mfma_f32_16x16x32_bf16 a[8:11], a[36:39], v[136:139], a[8:11]
  ds_read_b32 v224, v248 offset:64
  v_perm_b32 v82, v31, v83, v4
  v_mfma_f32_16x16x32_bf16 a[12:15], a[36:39], v[132:135], a[12:15]
  buffer_load_dwordx4 v[124:127], v3, s[36:39], s51 offen offset:2048
  v_mfma_f32_16x16x32_bf16 a[12:15], a[32:35], v[152:155], a[12:15]
  s_waitcnt vmcnt(21) lgkmcnt(6)
  ds_read_b128 a[36:39], v234
  v_add_u32_sdwa v235, v227, v5 dst_sel:DWORD dst_unused:UNUSED_PAD src0_sel:WORD_1 src1_sel:DWORD
  v_mfma_f32_16x16x32_bf16 a[28:31], a[44:47], v[152:155], a[28:31]
  s_add_u32 s51, s51, 2097152
  v_mov_b32_dpp v28, v16 row_ror:8 row_mask:0xf bank_mask:0xf
  v_mov_b32_dpp v29, v17 row_ror:8 row_mask:0xf bank_mask:0xf
  v_mfma_f32_16x16x32_bf16 a[28:31], a[40:43], v[132:135], a[28:31]
  v_mov_b32_dpp v30, v18 row_ror:8 row_mask:0xf bank_mask:0xf
  v_mov_b32_dpp v31, v19 row_ror:8 row_mask:0xf bank_mask:0xf
  v_mfma_f32_16x16x32_bf16 a[24:27], a[40:43], v[136:139], a[24:27]
  buffer_load_dword v252, v1, s[24:27], s55 offen offset:384
  v_mfma_f32_16x16x32_bf16 a[24:27], a[44:47], v[148:151], a[24:27]
  ds_read_b128 a[32:35], v234 offset:32
  v_perm_b32 v131, v28, v16, v4
  v_mfma_f32_16x16x32_bf16 a[20:23], a[44:47], v[144:147], a[20:23]
  v_perm_b32 v91, v29, v17, v4
  v_perm_b32 v87, v30, v18, v4
  v_mfma_f32_16x16x32_bf16 a[20:23], a[40:43], v[140:143], a[20:23]
  ds_read_b32 v225, v248 offset:3264
  v_perm_b32 v83, v31, v19, v4
  v_mfma_f32_16x16x32_bf16 a[16:19], a[40:43], v[156:159], a[16:19]
  buffer_load_dwordx4 v[152:155], v2, s[36:39], s52 offen
  v_mfma_f32_16x16x32_bf16 a[16:19], a[44:47], v[76:79], a[16:19]
  s_waitcnt vmcnt(20) lgkmcnt(7)
  ds_read_b128 a[40:43], v235
  v_mfma_f32_16x16x32_bf16 v[32:35], a[48:51], v[156:159], v[32:35]
  v_mov_b32_dpp v28, v104 row_ror:8 row_mask:0xf bank_mask:0xf
  v_mov_b32_dpp v29, v105 row_ror:8 row_mask:0xf bank_mask:0xf
  v_mfma_f32_16x16x32_bf16 v[32:35], a[52:55], v[128:131], v[32:35]
  v_mov_b32_dpp v30, v100 row_ror:8 row_mask:0xf bank_mask:0xf
  v_mov_b32_dpp v31, v106 row_ror:8 row_mask:0xf bank_mask:0xf
  v_mfma_f32_16x16x32_bf16 v[36:39], a[52:55], v[88:91], v[36:39]
  buffer_load_dword v1, v1, s[24:27], s55 offen offset:320
  v_mfma_f32_16x16x32_bf16 v[36:39], a[48:51], v[140:143], v[36:39]
  ds_read_b128 a[44:47], v235 offset:32
  v_perm_b32 v16, v28, v104, v4
  v_mfma_f32_16x16x32_bf16 v[40:43], a[48:51], v[136:139], v[40:43]
  v_perm_b32 v104, v29, v105, v4
  v_perm_b32 v17, v30, v100, v4
  v_mfma_f32_16x16x32_bf16 v[40:43], a[52:55], v[84:87], v[40:43]
  ds_read_b32 v226, v249 offset:64
  v_perm_b32 v100, v31, v106, v4
  v_mfma_f32_16x16x32_bf16 v[44:47], a[52:55], v[80:83], v[44:47]
  buffer_load_dwordx4 v[148:151], v2, s[36:39], s52 offen offset:2048
  v_mfma_f32_16x16x32_bf16 v[44:47], a[48:51], v[132:135], v[44:47]
  s_waitcnt vmcnt(21) lgkmcnt(7)
  ds_read_b128 a[52:55], v236 offset:32
  v_add_u32_sdwa v236, v228, v5 dst_sel:DWORD dst_unused:UNUSED_PAD src0_sel:WORD_0 src1_sel:DWORD
  v_mfma_f32_16x16x32_bf16 v[60:63], a[60:63], v[132:135], v[60:63]
  v_mov_b32_dpp v28, v101 row_ror:8 row_mask:0xf bank_mask:0xf
  v_mov_b32_dpp v29, v102 row_ror:8 row_mask:0xf bank_mask:0xf
  v_mfma_f32_16x16x32_bf16 v[60:63], a[56:59], v[80:83], v[60:63]
  v_mov_b32_dpp v30, v96 row_ror:8 row_mask:0xf bank_mask:0xf
  v_mov_b32_dpp v31, v107 row_ror:8 row_mask:0xf bank_mask:0xf
  v_mfma_f32_16x16x32_bf16 v[56:59], a[56:59], v[84:87], v[56:59]
  ds_read_u16 v244, v245 offset:192
  v_mfma_f32_16x16x32_bf16 v[56:59], a[60:63], v[136:139], v[56:59]
  ds_read_b128 a[48:51], v236
  v_perm_b32 v105, v28, v101, v4
  v_mfma_f32_16x16x32_bf16 v[52:55], a[60:63], v[140:143], v[52:55]
  v_perm_b32 v101, v29, v102, v4
  v_perm_b32 v18, v30, v96, v4
  v_mfma_f32_16x16x32_bf16 v[52:55], a[56:59], v[88:91], v[52:55]
  ds_read_b32 v227, v249 offset:3264
  v_perm_b32 v96, v31, v107, v4
  v_mfma_f32_16x16x32_bf16 v[48:51], a[56:59], v[128:131], v[48:51]
  s_waitcnt vmcnt(14)
  buffer_load_dwordx4 v[144:147], v3, s[36:39], s52 offen
  v_mfma_f32_16x16x32_bf16 v[48:51], a[60:63], v[156:159], v[48:51]
  s_waitcnt lgkmcnt(8)
  ds_read_b128 a[56:59], v237 offset:32
  v_add_u32_sdwa v237, v229, v5 dst_sel:DWORD dst_unused:UNUSED_PAD src0_sel:WORD_0 src1_sel:DWORD
  v_mfma_f32_16x16x32_bf16 v[160:163], a[36:39], v[156:159], v[160:163]
  v_mov_b32_dpp v28, v97 row_ror:8 row_mask:0xf bank_mask:0xf
  v_mov_b32_dpp v29, v103 row_ror:8 row_mask:0xf bank_mask:0xf
  v_mfma_f32_16x16x32_bf16 v[160:163], a[32:35], v[128:131], v[160:163]
  v_mov_b32_dpp v30, v98 row_ror:8 row_mask:0xf bank_mask:0xf
  v_mov_b32_dpp v31, v99 row_ror:8 row_mask:0xf bank_mask:0xf
  v_mfma_f32_16x16x32_bf16 v[164:167], a[32:35], v[88:91], v[164:167]
  ds_read_b128 a[128:131], v0 offset:4096
  v_mfma_f32_16x16x32_bf16 v[164:167], a[36:39], v[140:143], v[164:167]
  ds_read_b128 a[60:63], v237
  v_perm_b32 v106, v28, v97, v4
  v_mfma_f32_16x16x32_bf16 v[168:171], a[36:39], v[136:139], v[168:171]
  v_perm_b32 v97, v29, v103, v4
  v_perm_b32 v102, v30, v98, v4
  v_mfma_f32_16x16x32_bf16 v[168:171], a[32:35], v[84:87], v[168:171]
  ds_read_u16 v245, v245 offset:3392
  v_perm_b32 v98, v31, v99, v4
  v_mfma_f32_16x16x32_bf16 v[172:175], a[32:35], v[80:83], v[172:175]
  buffer_load_dwordx4 v[76:79], v3, s[36:39], s52 offen offset:2048
  v_mfma_f32_16x16x32_bf16 v[172:175], a[36:39], v[132:135], v[172:175]
  s_waitcnt lgkmcnt(9)
  ds_read_b128 a[32:35], v238 offset:32
  v_add_u32_sdwa v238, v230, v5 dst_sel:DWORD dst_unused:UNUSED_PAD src0_sel:WORD_0 src1_sel:DWORD
  v_mfma_f32_16x16x32_bf16 v[188:191], a[40:43], v[132:135], v[188:191]
  s_add_u32 s52, s52, 2097152
  v_mov_b32_dpp v28, v92 row_ror:8 row_mask:0xf bank_mask:0xf
  v_mov_b32_dpp v29, v93 row_ror:8 row_mask:0xf bank_mask:0xf
  v_mfma_f32_16x16x32_bf16 v[188:191], a[44:47], v[80:83], v[188:191]
  v_mov_b32_dpp v30, v94 row_ror:8 row_mask:0xf bank_mask:0xf
  v_mov_b32_dpp v31, v95 row_ror:8 row_mask:0xf bank_mask:0xf
  v_mfma_f32_16x16x32_bf16 v[184:187], a[44:47], v[84:87], v[184:187]
  ds_read_b128 a[132:135], v253 offset:4096
  v_mfma_f32_16x16x32_bf16 v[184:187], a[40:43], v[136:139], v[184:187]
  ds_read_b128 a[36:39], v238
  v_perm_b32 v19, v28, v92, v4
  v_mfma_f32_16x16x32_bf16 v[180:183], a[40:43], v[140:143], v[180:183]
  v_perm_b32 v107, v29, v93, v4
  v_perm_b32 v103, v30, v94, v4
  v_mfma_f32_16x16x32_bf16 v[180:183], a[44:47], v[88:91], v[180:183]
  ds_read_u16 v246, v247 offset:192
  v_perm_b32 v99, v31, v95, v4
  v_mfma_f32_16x16x32_bf16 v[176:179], a[44:47], v[128:131], v[176:179]
  buffer_load_dwordx4 v[132:135], v2, s[36:39], s53 offen
  v_mfma_f32_16x16x32_bf16 v[176:179], a[40:43], v[156:159], v[176:179]
  s_waitcnt lgkmcnt(9)
  ds_read_b128 a[44:47], v239 offset:32
  v_add_u32_sdwa v239, v231, v5 dst_sel:DWORD dst_unused:UNUSED_PAD src0_sel:WORD_0 src1_sel:DWORD
  v_mfma_f32_16x16x32_bf16 v[192:195], a[52:55], v[128:131], v[192:195]
  v_mov_b32_dpp v28, v120 row_ror:8 row_mask:0xf bank_mask:0xf
  v_mov_b32_dpp v29, v121 row_ror:8 row_mask:0xf bank_mask:0xf
  v_mfma_f32_16x16x32_bf16 v[192:195], a[48:51], v[16:19], v[192:195]
  v_mov_b32_dpp v30, v116 row_ror:8 row_mask:0xf bank_mask:0xf
  v_mov_b32_dpp v31, v122 row_ror:8 row_mask:0xf bank_mask:0xf
  v_mfma_f32_16x16x32_bf16 v[196:199], a[48:51], v[104:107], v[196:199]
  ds_read_b128 a[136:139], v254 offset:4096
  v_mfma_f32_16x16x32_bf16 v[196:199], a[52:55], v[88:91], v[196:199]
  ds_read_b128 a[40:43], v239
  v_perm_b32 v92, v28, v120, v4
  v_mfma_f32_16x16x32_bf16 v[200:203], a[52:55], v[84:87], v[200:203]
  v_perm_b32 v120, v29, v121, v4
  v_perm_b32 v93, v30, v116, v4
  v_mfma_f32_16x16x32_bf16 v[200:203], a[48:51], v[100:103], v[200:203]
  v_perm_b32 v116, v31, v122, v4
  v_add_u32_sdwa v232, v224, v5 dst_sel:DWORD dst_unused:UNUSED_PAD src0_sel:WORD_0 src1_sel:DWORD
  v_mfma_f32_16x16x32_bf16 v[204:207], a[48:51], v[96:99], v[204:207]
  buffer_load_dwordx4 v[136:139], v2, s[36:39], s53 offen offset:2048
  v_mfma_f32_16x16x32_bf16 v[204:207], a[52:55], v[80:83], v[204:207]
  s_waitcnt vmcnt(17) lgkmcnt(8)
  ds_read_b128 a[48:51], v232
  v_add_u32_sdwa v233, v225, v5 dst_sel:DWORD dst_unused:UNUSED_PAD src0_sel:WORD_0 src1_sel:DWORD
  v_mfma_f32_16x16x32_bf16 v[220:223], a[56:59], v[80:83], v[220:223]
  v_mov_b32_dpp v28, v117 row_ror:8 row_mask:0xf bank_mask:0xf
  v_mov_b32_dpp v29, v118 row_ror:8 row_mask:0xf bank_mask:0xf
  v_mfma_f32_16x16x32_bf16 v[220:223], a[60:63], v[96:99], v[220:223]
  v_mov_b32_dpp v30, v112 row_ror:8 row_mask:0xf bank_mask:0xf
  v_mov_b32_dpp v31, v123 row_ror:8 row_mask:0xf bank_mask:0xf
  v_mfma_f32_16x16x32_bf16 v[216:219], a[60:63], v[100:103], v[216:219]
  ds_read_b128 a[140:143], v255 offset:4096
  v_mfma_f32_16x16x32_bf16 v[216:219], a[56:59], v[84:87], v[216:219]
  ds_read_b128 a[52:55], v232 offset:32
  v_perm_b32 v121, v28, v117, v4
  v_mfma_f32_16x16x32_bf16 v[212:215], a[56:59], v[88:91], v[212:215]
  v_perm_b32 v117, v29, v118, v4
  v_perm_b32 v94, v30, v112, v4
  v_mfma_f32_16x16x32_bf16 v[212:215], a[60:63], v[104:107], v[212:215]
  v_perm_b32 v112, v31, v123, v4
  v_add_u32_dpp v26, v24, v20 row_newbcast:4 row_mask:0xf bank_mask:0xf
  v_mfma_f32_16x16x32_bf16 v[208:211], a[60:63], v[16:19], v[208:211]
  buffer_load_dwordx4 v[140:143], v3, s[36:39], s53 offen
  v_mfma_f32_16x16x32_bf16 v[208:211], a[56:59], v[128:131], v[208:211]
  s_waitcnt lgkmcnt(7)
  ds_read_b128 a[60:63], v233
  v_add_u32_sdwa v234, v226, v5 dst_sel:DWORD dst_unused:UNUSED_PAD src0_sel:WORD_0 src1_sel:DWORD
  v_mfma_f32_16x16x32_bf16 a[0:3], a[32:35], v[128:131], a[0:3]
  v_mov_b32_dpp v28, v113 row_ror:8 row_mask:0xf bank_mask:0xf
  v_mov_b32_dpp v29, v119 row_ror:8 row_mask:0xf bank_mask:0xf
  v_mfma_f32_16x16x32_bf16 a[0:3], a[36:39], v[16:19], a[0:3]
  s_add_u32 m0, s5, 0
  v_mov_b32_dpp v30, v114 row_ror:8 row_mask:0xf bank_mask:0xf
  v_mov_b32_dpp v31, v115 row_ror:8 row_mask:0xf bank_mask:0xf
  v_mfma_f32_16x16x32_bf16 a[4:7], a[36:39], v[104:107], a[4:7]
  buffer_load_dwordx4 v26, s[28:31], 0 offen lds
  v_mfma_f32_16x16x32_bf16 a[4:7], a[32:35], v[88:91], a[4:7]
  ds_read_b128 a[56:59], v233 offset:32
  v_perm_b32 v122, v28, v113, v4
  v_mfma_f32_16x16x32_bf16 a[8:11], a[32:35], v[84:87], a[8:11]
  v_perm_b32 v113, v29, v119, v4
  v_perm_b32 v118, v30, v114, v4
  v_mfma_f32_16x16x32_bf16 a[8:11], a[36:39], v[100:103], a[8:11]
  v_perm_b32 v114, v31, v115, v4
  v_add_u32_dpp v27, v24, v21 row_newbcast:5 row_mask:0xf bank_mask:0xf
  v_mfma_f32_16x16x32_bf16 a[12:15], a[36:39], v[96:99], a[12:15]
  buffer_load_dwordx4 v[156:159], v3, s[36:39], s53 offen offset:2048
  v_mfma_f32_16x16x32_bf16 a[12:15], a[32:35], v[80:83], a[12:15]
  s_waitcnt vmcnt(18) lgkmcnt(5)
  ds_read_b128 a[36:39], v234
  v_add_u32_sdwa v235, v227, v5 dst_sel:DWORD dst_unused:UNUSED_PAD src0_sel:WORD_0 src1_sel:DWORD
  v_mfma_f32_16x16x32_bf16 a[28:31], a[44:47], v[80:83], a[28:31]
  s_add_u32 s53, s53, 2097152
  v_mov_b32_dpp v28, v108 row_ror:8 row_mask:0xf bank_mask:0xf
  v_mov_b32_dpp v29, v109 row_ror:8 row_mask:0xf bank_mask:0xf
  v_mfma_f32_16x16x32_bf16 a[28:31], a[40:43], v[96:99], a[28:31]
  s_add_u32 m0, s5, 1024
  v_mov_b32_dpp v30, v110 row_ror:8 row_mask:0xf bank_mask:0xf
  v_mov_b32_dpp v31, v111 row_ror:8 row_mask:0xf bank_mask:0xf
  v_mfma_f32_16x16x32_bf16 a[24:27], a[40:43], v[100:103], a[24:27]
  buffer_load_dwordx4 v27, s[28:31], 0 offen lds
  v_mfma_f32_16x16x32_bf16 a[24:27], a[44:47], v[84:87], a[24:27]
  ds_read_b128 a[32:35], v234 offset:32
  v_perm_b32 v95, v28, v108, v4
  v_mfma_f32_16x16x32_bf16 a[20:23], a[44:47], v[88:91], a[20:23]
  v_perm_b32 v123, v29, v109, v4
  v_perm_b32 v119, v30, v110, v4
  v_mfma_f32_16x16x32_bf16 a[20:23], a[40:43], v[104:107], a[20:23]
  ds_read_u16 v247, v247 offset:3392
  v_perm_b32 v115, v31, v111, v4
  v_mfma_f32_16x16x32_bf16 a[16:19], a[40:43], v[16:19], a[16:19]
  buffer_load_dwordx4 v[80:83], v2, s[36:39], s50 offen
  v_mfma_f32_16x16x32_bf16 a[16:19], a[44:47], v[128:131], a[16:19]
  s_waitcnt vmcnt(17) lgkmcnt(5)
  ds_read_b128 a[40:43], v235
  v_add_u32_dpp v26, v24, v22 row_newbcast:6 row_mask:0xf bank_mask:0xf
  v_mfma_f32_16x16x32_bf16 v[32:35], a[48:51], v[16:19], v[32:35]
  v_mov_b32_dpp v28, v72 row_ror:8 row_mask:0xf bank_mask:0xf
  v_mov_b32_dpp v29, v73 row_ror:8 row_mask:0xf bank_mask:0xf
  v_mfma_f32_16x16x32_bf16 v[32:35], a[52:55], v[92:95], v[32:35]
  s_add_u32 m0, s5, 2048
  v_mov_b32_dpp v30, v68 row_ror:8 row_mask:0xf bank_mask:0xf
  v_mov_b32_dpp v31, v74 row_ror:8 row_mask:0xf bank_mask:0xf
  v_mfma_f32_16x16x32_bf16 v[36:39], a[52:55], v[120:123], v[36:39]
  buffer_load_dwordx4 v26, s[28:31], 0 offen lds
  v_mfma_f32_16x16x32_bf16 v[36:39], a[48:51], v[104:107], v[36:39]
  ds_read_b128 a[44:47], v235 offset:32
  v_perm_b32 v108, v28, v72, v4
  v_mfma_f32_16x16x32_bf16 v[40:43], a[48:51], v[100:103], v[40:43]
  v_perm_b32 v72, v29, v73, v4
  v_perm_b32 v109, v30, v68, v4
  v_mfma_f32_16x16x32_bf16 v[40:43], a[52:55], v[116:119], v[40:43]
  v_perm_b32 v68, v31, v74, v4
  v_add_u32_dpp v27, v24, v23 row_newbcast:7 row_mask:0xf bank_mask:0xf
  v_mfma_f32_16x16x32_bf16 v[44:47], a[52:55], v[112:115], v[44:47]
  buffer_load_dwordx4 v[84:87], v2, s[36:39], s50 offen offset:2048
  v_mfma_f32_16x16x32_bf16 v[44:47], a[48:51], v[96:99], v[44:47]
  s_waitcnt vmcnt(17) lgkmcnt(5)
  ds_read_b128 a[52:55], v236 offset:32
  v_add_u32_sdwa v236, v228, v5 dst_sel:DWORD dst_unused:UNUSED_PAD src0_sel:WORD_1 src1_sel:DWORD
  v_mfma_f32_16x16x32_bf16 v[60:63], a[60:63], v[96:99], v[60:63]
  v_mov_b32_dpp v28, v69 row_ror:8 row_mask:0xf bank_mask:0xf
  v_mov_b32_dpp v29, v70 row_ror:8 row_mask:0xf bank_mask:0xf
  v_mfma_f32_16x16x32_bf16 v[60:63], a[56:59], v[112:115], v[60:63]
  s_add_u32 m0, s5, 3072
  v_mov_b32_dpp v30, v64 row_ror:8 row_mask:0xf bank_mask:0xf
  v_mov_b32_dpp v31, v75 row_ror:8 row_mask:0xf bank_mask:0xf
  v_mfma_f32_16x16x32_bf16 v[56:59], a[56:59], v[116:119], v[56:59]
  buffer_load_dwordx4 v27, s[28:31], 0 offen lds
  v_mfma_f32_16x16x32_bf16 v[56:59], a[60:63], v[100:103], v[56:59]
  ds_read_b128 a[48:51], v236
  v_perm_b32 v73, v28, v69, v4
  v_mfma_f32_16x16x32_bf16 v[52:55], a[60:63], v[104:107], v[52:55]
  v_perm_b32 v69, v29, v70, v4
  v_perm_b32 v110, v30, v64, v4
  v_mfma_f32_16x16x32_bf16 v[52:55], a[56:59], v[120:123], v[52:55]
  ds_read_b32 v228, v250 offset:96
  v_perm_b32 v64, v31, v75, v4
  v_mfma_f32_16x16x32_bf16 v[48:51], a[56:59], v[92:95], v[48:51]
  s_waitcnt lgkmcnt(5)
  buffer_load_dwordx4 v[88:91], v3, s[36:39], s50 offen
  v_mfma_f32_16x16x32_bf16 v[48:51], a[60:63], v[16:19], v[48:51]
  ds_read_b128 a[56:59], v237 offset:32
  v_add_u32_sdwa v237, v229, v5 dst_sel:DWORD dst_unused:UNUSED_PAD src0_sel:WORD_1 src1_sel:DWORD
  v_mfma_f32_16x16x32_bf16 v[160:163], a[36:39], v[16:19], v[160:163]
  v_mov_b32_dpp v28, v65 row_ror:8 row_mask:0xf bank_mask:0xf
  v_mov_b32_dpp v29, v71 row_ror:8 row_mask:0xf bank_mask:0xf
  v_mfma_f32_16x16x32_bf16 v[160:163], a[32:35], v[92:95], v[160:163]
  s_add_u32 m0, s56, 4096
  v_mov_b32_dpp v30, v66 row_ror:8 row_mask:0xf bank_mask:0xf
  v_mov_b32_dpp v31, v67 row_ror:8 row_mask:0xf bank_mask:0xf
  v_mfma_f32_16x16x32_bf16 v[164:167], a[32:35], v[120:123], v[164:167]
  s_mov_b32 s4, 4096
  buffer_load_dwordx4 v8, s[32:35], s4 offen lds
  v_mfma_f32_16x16x32_bf16 v[164:167], a[36:39], v[104:107], v[164:167]
  ds_read_b128 a[60:63], v237
  v_perm_b32 v74, v28, v65, v4
  v_mfma_f32_16x16x32_bf16 v[168:171], a[36:39], v[100:103], v[168:171]
  v_perm_b32 v65, v29, v71, v4
  v_perm_b32 v70, v30, v66, v4
  v_mfma_f32_16x16x32_bf16 v[168:171], a[32:35], v[116:119], v[168:171]
  ds_read_b32 v229, v250 offset:3296
  v_perm_b32 v66, v31, v67, v4
  v_mfma_f32_16x16x32_bf16 v[172:175], a[32:35], v[112:115], v[172:175]
  buffer_load_dwordx4 v[128:131], v3, s[36:39], s50 offen offset:2048
  v_mfma_f32_16x16x32_bf16 v[172:175], a[36:39], v[96:99], v[172:175]
  s_waitcnt vmcnt(19) lgkmcnt(6)
  ds_read_b128 a[32:35], v238 offset:32
  v_add_u32_sdwa v238, v230, v5 dst_sel:DWORD dst_unused:UNUSED_PAD src0_sel:WORD_1 src1_sel:DWORD
  v_mfma_f32_16x16x32_bf16 v[188:191], a[40:43], v[96:99], v[188:191]
  s_add_u32 s50, s50, 2097152
  v_mov_b32_dpp v28, v124 row_ror:8 row_mask:0xf bank_mask:0xf
  v_mov_b32_dpp v29, v125 row_ror:8 row_mask:0xf bank_mask:0xf
  v_mfma_f32_16x16x32_bf16 v[188:191], a[44:47], v[112:115], v[188:191]
  v_mov_b32_dpp v30, v126 row_ror:8 row_mask:0xf bank_mask:0xf
  v_mov_b32_dpp v31, v127 row_ror:8 row_mask:0xf bank_mask:0xf
  v_mfma_f32_16x16x32_bf16 v[184:187], a[44:47], v[116:119], v[184:187]
  buffer_load_dword v9, v6, s[36:39], s54 offen
  v_mfma_f32_16x16x32_bf16 v[184:187], a[40:43], v[100:103], v[184:187]
  s_add_u32 s54, s54, 2097152
  ds_read_b128 a[36:39], v238
  v_perm_b32 v111, v28, v124, v4
  v_mfma_f32_16x16x32_bf16 v[180:183], a[40:43], v[104:107], v[180:183]
  s_waitcnt vmcnt(17)
  v_perm_b32 v75, v29, v125, v4
  v_perm_b32 v71, v30, v126, v4
  v_mfma_f32_16x16x32_bf16 v[180:183], a[44:47], v[120:123], v[180:183]
  s_mov_b32 vcc_lo, 983055
  ds_read_b32 v230, v251 offset:96
  v_perm_b32 v67, v31, v127, v4
  v_mfma_f32_16x16x32_bf16 v[176:179], a[44:47], v[92:95], v[176:179]
  s_mov_b32 vcc_hi, 983055
  buffer_load_dwordx4 v[96:99], v2, s[36:39], s51 offen
  v_mfma_f32_16x16x32_bf16 v[176:179], a[40:43], v[16:19], v[176:179]
  s_waitcnt vmcnt(17) lgkmcnt(7)
  ds_read_b128 a[44:47], v239 offset:32
  v_add_u32_sdwa v239, v231, v5 dst_sel:DWORD dst_unused:UNUSED_PAD src0_sel:WORD_1 src1_sel:DWORD
  v_mfma_f32_16x16x32_bf16 v[192:195], a[52:55], v[92:95], v[192:195]
  v_mov_b32_dpp v28, v152 row_ror:8 row_mask:0xf bank_mask:0xf
  v_mov_b32_dpp v29, v153 row_ror:8 row_mask:0xf bank_mask:0xf
  v_mfma_f32_16x16x32_bf16 v[192:195], a[48:51], v[108:111], v[192:195]
  v_mov_b32_dpp v30, v148 row_ror:8 row_mask:0xf bank_mask:0xf
  v_mov_b32_dpp v31, v154 row_ror:8 row_mask:0xf bank_mask:0xf
  v_mfma_f32_16x16x32_bf16 v[196:199], a[48:51], v[72:75], v[196:199]
  global_load_dword v12, v5, s[0:1]
  v_mfma_f32_16x16x32_bf16 v[196:199], a[52:55], v[120:123], v[196:199]
  ds_read_b128 a[40:43], v239
  v_perm_b32 v124, v28, v152, v4
  v_mfma_f32_16x16x32_bf16 v[200:203], a[52:55], v[116:119], v[200:203]
  v_perm_b32 v152, v29, v153, v4
  v_perm_b32 v125, v30, v148, v4
  v_mfma_f32_16x16x32_bf16 v[200:203], a[48:51], v[68:71], v[200:203]
  v_perm_b32 v148, v31, v154, v4
  v_add_u32_sdwa v232, v224, v5 dst_sel:DWORD dst_unused:UNUSED_PAD src0_sel:WORD_1 src1_sel:DWORD
  v_mfma_f32_16x16x32_bf16 v[204:207], a[48:51], v[64:67], v[204:207]
  buffer_load_dwordx4 v[100:103], v2, s[36:39], s51 offen offset:2048
  v_mfma_f32_16x16x32_bf16 v[204:207], a[52:55], v[112:115], v[204:207]
  s_waitcnt vmcnt(18) lgkmcnt(6)
  ds_read_b128 a[48:51], v232
  v_add_u32_sdwa v233, v225, v5 dst_sel:DWORD dst_unused:UNUSED_PAD src0_sel:WORD_1 src1_sel:DWORD
  v_mfma_f32_16x16x32_bf16 v[220:223], a[56:59], v[112:115], v[220:223]
  v_mov_b32_dpp v28, v149 row_ror:8 row_mask:0xf bank_mask:0xf
  v_mov_b32_dpp v29, v150 row_ror:8 row_mask:0xf bank_mask:0xf
  v_mfma_f32_16x16x32_bf16 v[220:223], a[60:63], v[64:67], v[220:223]
  v_mov_b32_dpp v30, v144 row_ror:8 row_mask:0xf bank_mask:0xf
  v_mov_b32_dpp v31, v155 row_ror:8 row_mask:0xf bank_mask:0xf
  v_mfma_f32_16x16x32_bf16 v[216:219], a[60:63], v[68:71], v[216:219]
  buffer_store_dwordx4 a[248:251], v8, s[40:43], s63 offen sc1
  v_mfma_f32_16x16x32_bf16 v[216:219], a[56:59], v[116:119], v[216:219]
  s_xor_b32 s63, s63, 4096
  ds_read_b128 a[52:55], v232 offset:32
  v_perm_b32 v153, v28, v149, v4
  v_mfma_f32_16x16x32_bf16 v[212:215], a[56:59], v[120:123], v[212:215]
  v_perm_b32 v149, v29, v150, v4
  v_perm_b32 v126, v30, v144, v4
  v_mfma_f32_16x16x32_bf16 v[212:215], a[60:63], v[72:75], v[212:215]
  ds_read_b32 v231, v251 offset:3296
  v_perm_b32 v144, v31, v155, v4
  v_mfma_f32_16x16x32_bf16 v[208:211], a[60:63], v[108:111], v[208:211]
  buffer_load_dwordx4 v[104:107], v3, s[36:39], s51 offen
  v_mfma_f32_16x16x32_bf16 v[208:211], a[56:59], v[92:95], v[208:211]
  s_waitcnt lgkmcnt(6)
  ds_read_b128 a[60:63], v233
  v_add_u32_sdwa v234, v226, v5 dst_sel:DWORD dst_unused:UNUSED_PAD src0_sel:WORD_1 src1_sel:DWORD
  v_mfma_f32_16x16x32_bf16 a[0:3], a[32:35], v[92:95], a[0:3]
  v_mov_b32_dpp v28, v145 row_ror:8 row_mask:0xf bank_mask:0xf
  v_mov_b32_dpp v29, v151 row_ror:8 row_mask:0xf bank_mask:0xf
  v_mfma_f32_16x16x32_bf16 a[0:3], a[36:39], v[108:111], a[0:3]
  v_mov_b32_dpp v30, v146 row_ror:8 row_mask:0xf bank_mask:0xf
  v_mov_b32_dpp v31, v147 row_ror:8 row_mask:0xf bank_mask:0xf
  v_mfma_f32_16x16x32_bf16 a[4:7], a[36:39], v[72:75], a[4:7]
  v_add_u32 v240, v240, v7
  v_lshl_add_u32 v252, v252, 7, v7
  v_mfma_f32_16x16x32_bf16 a[4:7], a[32:35], v[120:123], a[4:7]
  ds_read_b128 a[56:59], v233 offset:32
  v_perm_b32 v154, v28, v145, v4
  v_mfma_f32_16x16x32_bf16 a[8:11], a[32:35], v[116:119], a[8:11]
  v_perm_b32 v145, v29, v151, v4
  v_perm_b32 v150, v30, v146, v4
  v_mfma_f32_16x16x32_bf16 a[8:11], a[36:39], v[68:71], a[8:11]
  ds_read_b32 v224, v248 offset:96
  v_perm_b32 v146, v31, v147, v4
  v_mfma_f32_16x16x32_bf16 a[12:15], a[36:39], v[64:67], a[12:15]
  buffer_load_dwordx4 v[16:19], v3, s[36:39], s51 offen offset:2048
  v_mfma_f32_16x16x32_bf16 a[12:15], a[32:35], v[112:115], a[12:15]
  s_waitcnt vmcnt(20) lgkmcnt(6)
  ds_read_b128 a[36:39], v234
  v_add_u32_sdwa v235, v227, v5 dst_sel:DWORD dst_unused:UNUSED_PAD src0_sel:WORD_1 src1_sel:DWORD
  v_mfma_f32_16x16x32_bf16 a[28:31], a[44:47], v[112:115], a[28:31]
  s_add_u32 s51, s51, 2097152
  v_mov_b32_dpp v28, v76 row_ror:8 row_mask:0xf bank_mask:0xf
  v_mov_b32_dpp v29, v77 row_ror:8 row_mask:0xf bank_mask:0xf
  v_mfma_f32_16x16x32_bf16 a[28:31], a[40:43], v[64:67], a[28:31]
  v_mov_b32_dpp v30, v78 row_ror:8 row_mask:0xf bank_mask:0xf
  v_mov_b32_dpp v31, v79 row_ror:8 row_mask:0xf bank_mask:0xf
  v_mfma_f32_16x16x32_bf16 a[24:27], a[40:43], v[68:71], a[24:27]
  v_add_u32 v241, v241, v7
  v_lshl_add_u32 v25, v25, 8, v7
  v_mfma_f32_16x16x32_bf16 a[24:27], a[44:47], v[116:119], a[24:27]
  ds_read_b128 a[32:35], v234 offset:32
  v_perm_b32 v127, v28, v76, v4
  v_mfma_f32_16x16x32_bf16 a[20:23], a[44:47], v[120:123], a[20:23]
  v_perm_b32 v155, v29, v77, v4
  v_perm_b32 v151, v30, v78, v4
  v_mfma_f32_16x16x32_bf16 a[20:23], a[40:43], v[72:75], a[20:23]
Lsh1:
Lst2:
  s_cbranch_execz Lst3
  ds_read_b32 v225, v248 offset:3296
  v_perm_b32 v147, v31, v79, v4
  v_mfma_f32_16x16x32_bf16 a[16:19], a[40:43], v[108:111], a[16:19]
  buffer_load_dwordx4 v[112:115], v2, s[36:39], s52 offen
  v_mfma_f32_16x16x32_bf16 a[16:19], a[44:47], v[92:95], a[16:19]
  s_waitcnt vmcnt(19) lgkmcnt(7)
  ds_read_b128 a[40:43], v235
  v_add_u32 v242, v242, v7
  v_mfma_f32_16x16x32_bf16 v[32:35], a[48:51], v[108:111], v[32:35]
  v_mov_b32_dpp v28, v132 row_ror:8 row_mask:0xf bank_mask:0xf
  v_mov_b32_dpp v29, v133 row_ror:8 row_mask:0xf bank_mask:0xf
  v_mfma_f32_16x16x32_bf16 v[32:35], a[52:55], v[124:127], v[32:35]
  v_mov_b32_dpp v30, v136 row_ror:8 row_mask:0xf bank_mask:0xf
  v_mov_b32_dpp v31, v134 row_ror:8 row_mask:0xf bank_mask:0xf
  v_mfma_f32_16x16x32_bf16 v[36:39], a[52:55], v[152:155], v[36:39]
  v_add_u32 v243, v243, v7
  v_lshl_add_u32 v1, v1, 8, v7
  v_mfma_f32_16x16x32_bf16 v[36:39], a[48:51], v[72:75], v[36:39]
  ds_read_b128 a[44:47], v235 offset:32
  v_perm_b32 v76, v28, v132, v4
  v_mfma_f32_16x16x32_bf16 v[40:43], a[48:51], v[68:71], v[40:43]
  v_perm_b32 v132, v29, v133, v4
  v_perm_b32 v77, v30, v136, v4
  v_mfma_f32_16x16x32_bf16 v[40:43], a[52:55], v[148:151], v[40:43]
  ds_read_b32 v226, v249 offset:96
  v_perm_b32 v136, v31, v134, v4
  v_mfma_f32_16x16x32_bf16 v[44:47], a[52:55], v[144:147], v[44:47]
  buffer_load_dwordx4 v[116:119], v2, s[36:39], s52 offen offset:2048
  v_mfma_f32_16x16x32_bf16 v[44:47], a[48:51], v[64:67], v[44:47]
  s_waitcnt vmcnt(19) lgkmcnt(7)
  ds_read_b128 a[52:55], v236 offset:32
  v_add_u32_sdwa v236, v228, v5 dst_sel:DWORD dst_unused:UNUSED_PAD src0_sel:WORD_0 src1_sel:DWORD
  v_mfma_f32_16x16x32_bf16 v[60:63], a[60:63], v[64:67], v[60:63]
  v_mov_b32_dpp v28, v137 row_ror:8 row_mask:0xf bank_mask:0xf
  v_mov_b32_dpp v29, v138 row_ror:8 row_mask:0xf bank_mask:0xf
  v_mfma_f32_16x16x32_bf16 v[60:63], a[56:59], v[144:147], v[60:63]
  v_mov_b32_dpp v30, v140 row_ror:8 row_mask:0xf bank_mask:0xf
  v_mov_b32_dpp v31, v135 row_ror:8 row_mask:0xf bank_mask:0xf
  v_mfma_f32_16x16x32_bf16 v[56:59], a[56:59], v[148:151], v[56:59]
  v_add_u32 v244, v244, v7
  v_lshlrev_b32 v252, 1, v252
  v_mfma_f32_16x16x32_bf16 v[56:59], a[60:63], v[68:71], v[56:59]
  ds_read_b128 a[48:51], v236
  v_perm_b32 v133, v28, v137, v4
  v_mfma_f32_16x16x32_bf16 v[52:55], a[60:63], v[72:75], v[52:55]
  v_perm_b32 v137, v29, v138, v4
  v_perm_b32 v78, v30, v140, v4
  v_mfma_f32_16x16x32_bf16 v[52:55], a[56:59], v[152:155], v[52:55]
  ds_read_b32 v227, v249 offset:3296
  v_perm_b32 v140, v31, v135, v4
  v_mfma_f32_16x16x32_bf16 v[48:51], a[56:59], v[124:127], v[48:51]
  s_waitcnt vmcnt(12)
  buffer_load_dwordx4 v[120:123], v3, s[36:39], s52 offen
  v_mfma_f32_16x16x32_bf16 v[48:51], a[60:63], v[108:111], v[48:51]
  s_waitcnt lgkmcnt(7)
  ds_read_b128 a[56:59], v237 offset:32
  v_add_u32_sdwa v237, v229, v5 dst_sel:DWORD dst_unused:UNUSED_PAD src0_sel:WORD_0 src1_sel:DWORD
  v_mfma_f32_16x16x32_bf16 v[160:163], a[36:39], v[108:111], v[160:163]
  v_mov_b32_dpp v28, v141 row_ror:8 row_mask:0xf bank_mask:0xf
  v_mov_b32_dpp v29, v139 row_ror:8 row_mask:0xf bank_mask:0xf
  v_mfma_f32_16x16x32_bf16 v[160:163], a[32:35], v[124:127], v[160:163]
  v_mov_b32_dpp v30, v142 row_ror:8 row_mask:0xf bank_mask:0xf
  v_mov_b32_dpp v31, v143 row_ror:8 row_mask:0xf bank_mask:0xf
  v_mfma_f32_16x16x32_bf16 v[164:167], a[32:35], v[152:155], v[164:167]
  ds_read_b128 a[144:147], v0 offset:0
  v_add_u32 v245, v245, v7
  v_mfma_f32_16x16x32_bf16 v[164:167], a[36:39], v[72:75], v[164:167]
  ds_read_b128 a[60:63], v237
  v_perm_b32 v134, v28, v141, v4
  v_mfma_f32_16x16x32_bf16 v[168:171], a[36:39], v[68:71], v[168:171]
  v_perm_b32 v141, v29, v139, v4
  v_perm_b32 v138, v30, v142, v4
  v_mfma_f32_16x16x32_bf16 v[168:171], a[32:35], v[148:151], v[168:171]
  v_perm_b32 v142, v31, v143, v4
  v_add_u32 v246, v246, v7
  v_mfma_f32_16x16x32_bf16 v[172:175], a[32:35], v[144:147], v[172:175]
  buffer_load_dwordx4 v[92:95], v3, s[36:39], s52 offen offset:2048
  v_mfma_f32_16x16x32_bf16 v[172:175], a[36:39], v[64:67], v[172:175]
  s_waitcnt lgkmcnt(7)
  ds_read_b128 a[32:35], v238 offset:32
  v_add_u32_sdwa v238, v230, v5 dst_sel:DWORD dst_unused:UNUSED_PAD src0_sel:WORD_0 src1_sel:DWORD
  v_mfma_f32_16x16x32_bf16 v[188:191], a[40:43], v[64:67], v[188:191]
  s_add_u32 s52, s52, 2097152
  v_mov_b32_dpp v28, v156 row_ror:8 row_mask:0xf bank_mask:0xf
  v_mov_b32_dpp v29, v157 row_ror:8 row_mask:0xf bank_mask:0xf
  v_mfma_f32_16x16x32_bf16 v[188:191], a[44:47], v[144:147], v[188:191]
  v_mov_b32_dpp v30, v158 row_ror:8 row_mask:0xf bank_mask:0xf
  v_mov_b32_dpp v31, v159 row_ror:8 row_mask:0xf bank_mask:0xf
  v_mfma_f32_16x16x32_bf16 v[184:187], a[44:47], v[148:151], v[184:187]
  ds_read_b128 a[148:151], v253 offset:0
  v_add_u32 v247, v247, v7
  v_mfma_f32_16x16x32_bf16 v[184:187], a[40:43], v[68:71], v[184:187]
  ds_read_b128 a[36:39], v238
  v_perm_b32 v79, v28, v156, v4
  v_mfma_f32_16x16x32_bf16 v[180:183], a[40:43], v[72:75], v[180:183]
  v_perm_b32 v135, v29, v157, v4
  v_perm_b32 v139, v30, v158, v4
  v_mfma_f32_16x16x32_bf16 v[180:183], a[44:47], v[152:155], v[180:183]
  v_perm_b32 v143, v31, v159, v4
  v_cndmask_b32 v252, v4, v252, vcc
  v_mfma_f32_16x16x32_bf16 v[176:179], a[44:47], v[124:127], v[176:179]
  buffer_load_dwordx4 v[64:67], v2, s[36:39], s53 offen
  v_mfma_f32_16x16x32_bf16 v[176:179], a[40:43], v[108:111], v[176:179]
  s_waitcnt lgkmcnt(7)
  ds_read_b128 a[44:47], v239 offset:32
  v_add_u32_sdwa v239, v231, v5 dst_sel:DWORD dst_unused:UNUSED_PAD src0_sel:WORD_0 src1_sel:DWORD
  v_mfma_f32_16x16x32_bf16 v[192:195], a[52:55], v[124:127], v[192:195]
  v_mov_b32_dpp v28, v80 row_ror:8 row_mask:0xf bank_mask:0xf
  v_mov_b32_dpp v29, v81 row_ror:8 row_mask:0xf bank_mask:0xf
  v_mfma_f32_16x16x32_bf16 v[192:195], a[48:51], v[76:79], v[192:195]
  v_mov_b32_dpp v30, v84 row_ror:8 row_mask:0xf bank_mask:0xf
  v_mov_b32_dpp v31, v82 row_ror:8 row_mask:0xf bank_mask:0xf
  v_mfma_f32_16x16x32_bf16 v[196:199], a[48:51], v[132:135], v[196:199]
  ds_read_b128 a[152:155], v254 offset:0
  v_mfma_f32_16x16x32_bf16 v[196:199], a[52:55], v[152:155], v[196:199]
  ds_read_b128 a[40:43], v239
  v_perm_b32 v156, v28, v80, v4
  v_mfma_f32_16x16x32_bf16 v[200:203], a[52:55], v[148:151], v[200:203]
  v_perm_b32 v80, v29, v81, v4
  v_perm_b32 v157, v30, v84, v4
  v_mfma_f32_16x16x32_bf16 v[200:203], a[48:51], v[136:139], v[200:203]
  v_perm_b32 v84, v31, v82, v4
  v_add_u32_sdwa v232, v224, v5 dst_sel:DWORD dst_unused:UNUSED_PAD src0_sel:WORD_0 src1_sel:DWORD
  v_mfma_f32_16x16x32_bf16 v[204:207], a[48:51], v[140:143], v[204:207]
  buffer_load_dwordx4 v[68:71], v2, s[36:39], s53 offen offset:2048
  v_mfma_f32_16x16x32_bf16 v[204:207], a[52:55], v[144:147], v[204:207]
  s_waitcnt vmcnt(15) lgkmcnt(6)
  ds_read_b128 a[48:51], v232
  v_add_u32_sdwa v233, v225, v5 dst_sel:DWORD dst_unused:UNUSED_PAD src0_sel:WORD_0 src1_sel:DWORD
  v_mfma_f32_16x16x32_bf16 v[220:223], a[56:59], v[144:147], v[220:223]
  v_mov_b32_dpp v28, v85 row_ror:8 row_mask:0xf bank_mask:0xf
  v_mov_b32_dpp v29, v86 row_ror:8 row_mask:0xf bank_mask:0xf
  v_mfma_f32_16x16x32_bf16 v[220:223], a[60:63], v[140:143], v[220:223]
  v_mov_b32_dpp v30, v88 row_ror:8 row_mask:0xf bank_mask:0xf
  v_mov_b32_dpp v31, v83 row_ror:8 row_mask:0xf bank_mask:0xf
  v_mfma_f32_16x16x32_bf16 v[216:219], a[60:63], v[136:139], v[216:219]
  ds_read_b128 a[156:159], v255 offset:0
  v_mfma_f32_16x16x32_bf16 v[216:219], a[56:59], v[148:151], v[216:219]
  ds_read_b128 a[52:55], v232 offset:32
  v_perm_b32 v81, v28, v85, v4
  v_mfma_f32_16x16x32_bf16 v[212:215], a[56:59], v[152:155], v[212:215]
  v_perm_b32 v85, v29, v86, v4
  v_perm_b32 v158, v30, v88, v4
  v_mfma_f32_16x16x32_bf16 v[212:215], a[60:63], v[132:135], v[212:215]
  v_perm_b32 v88, v31, v83, v4
  v_add_u32_dpp v26, v24, v20 row_newbcast:8 row_mask:0xf bank_mask:0xf
  v_mfma_f32_16x16x32_bf16 v[208:211], a[60:63], v[76:79], v[208:211]
  buffer_load_dwordx4 v[72:75], v3, s[36:39], s53 offen
  v_mfma_f32_16x16x32_bf16 v[208:211], a[56:59], v[124:127], v[208:211]
  s_waitcnt lgkmcnt(6)
  ds_read_b128 a[60:63], v233
  v_add_u32_sdwa v234, v226, v5 dst_sel:DWORD dst_unused:UNUSED_PAD src0_sel:WORD_0 src1_sel:DWORD
  v_mfma_f32_16x16x32_bf16 a[0:3], a[32:35], v[124:127], a[0:3]
  v_mov_b32_dpp v28, v89 row_ror:8 row_mask:0xf bank_mask:0xf
  v_mov_b32_dpp v29, v87 row_ror:8 row_mask:0xf bank_mask:0xf
  v_mfma_f32_16x16x32_bf16 a[0:3], a[36:39], v[76:79], a[0:3]
  s_add_u32 m0, s5, 8192
  v_mov_b32_dpp v30, v90 row_ror:8 row_mask:0xf bank_mask:0xf
  v_mov_b32_dpp v31, v91 row_ror:8 row_mask:0xf bank_mask:0xf
  v_mfma_f32_16x16x32_bf16 a[4:7], a[36:39], v[132:135], a[4:7]
  buffer_load_dwordx4 v26, s[28:31], 0 offen lds
  v_mfma_f32_16x16x32_bf16 a[4:7], a[32:35], v[152:155], a[4:7]
  ds_read_b128 a[56:59], v233 offset:32
  v_perm_b32 v82, v28, v89, v4
  v_mfma_f32_16x16x32_bf16 a[8:11], a[32:35], v[148:151], a[8:11]
  v_perm_b32 v89, v29, v87, v4
  v_perm_b32 v86, v30, v90, v4
  v_mfma_f32_16x16x32_bf16 a[8:11], a[36:39], v[136:139], a[8:11]
  v_perm_b32 v90, v31, v91, v4
  v_add_u32_dpp v27, v24, v21 row_newbcast:9 row_mask:0xf bank_mask:0xf
  v_mfma_f32_16x16x32_bf16 a[12:15], a[36:39], v[140:143], a[12:15]
  buffer_load_dwordx4 v[108:111], v3, s[36:39], s53 offen offset:2048
  v_mfma_f32_16x16x32_bf16 a[12:15], a[32:35], v[144:147], a[12:15]
  s_waitcnt vmcnt(16) lgkmcnt(5)
  ds_read_b128 a[36:39], v234
  v_add_u32_sdwa v235, v227, v5 dst_sel:DWORD dst_unused:UNUSED_PAD src0_sel:WORD_0 src1_sel:DWORD
  v_mfma_f32_16x16x32_bf16 a[28:31], a[44:47], v[144:147], a[28:31]
  s_add_u32 s53, s53, 2097152
  v_mov_b32_dpp v28, v128 row_ror:8 row_mask:0xf bank_mask:0xf
  v_mov_b32_dpp v29, v129 row_ror:8 row_mask:0xf bank_mask:0xf
  v_mfma_f32_16x16x32_bf16 a[28:31], a[40:43], v[140:143], a[28:31]
  s_add_u32 m0, s5, 9216
  v_mov_b32_dpp v30, v130 row_ror:8 row_mask:0xf bank_mask:0xf
  v_mov_b32_dpp v31, v131 row_ror:8 row_mask:0xf bank_mask:0xf
  v_mfma_f32_16x16x32_bf16 a[24:27], a[40:43], v[136:139], a[24:27]
  buffer_load_dwordx4 v27, s[28:31], 0 offen lds
  v_mfma_f32_16x16x32_bf16 a[24:27], a[44:47], v[148:151], a[24:27]
  ds_read_b128 a[32:35], v234 offset:32
  v_perm_b32 v159, v28, v128, v4
  v_mfma_f32_16x16x32_bf16 a[20:23], a[44:47], v[152:155], a[20:23]
  v_perm_b32 v83, v29, v129, v4
  v_perm_b32 v87, v30, v130, v4
  v_mfma_f32_16x16x32_bf16 a[20:23], a[40:43], v[132:135], a[20:23]
  v_perm_b32 v91, v31, v131, v4
  v_mfma_f32_16x16x32_bf16 a[16:19], a[40:43], v[76:79], a[16:19]
  buffer_load_dwordx4 v[144:147], v2, s[36:39], s50 offen
  v_mfma_f32_16x16x32_bf16 a[16:19], a[44:47], v[124:127], a[16:19]
  s_waitcnt vmcnt(14) lgkmcnt(4)
  ds_read_b128 a[40:43], v235
  v_add_u32_dpp v26, v24, v22 row_newbcast:10 row_mask:0xf bank_mask:0xf
  v_mfma_f32_16x16x32_bf16 v[32:35], a[48:51], v[76:79], v[32:35]
  v_mov_b32_dpp v28, v96 row_ror:8 row_mask:0xf bank_mask:0xf
  v_mov_b32_dpp v29, v97 row_ror:8 row_mask:0xf bank_mask:0xf
  v_mfma_f32_16x16x32_bf16 v[32:35], a[52:55], v[156:159], v[32:35]
  s_add_u32 m0, s5, 10240
  v_mov_b32_dpp v30, v100 row_ror:8 row_mask:0xf bank_mask:0xf
  v_mov_b32_dpp v31, v98 row_ror:8 row_mask:0xf bank_mask:0xf
  v_mfma_f32_16x16x32_bf16 v[36:39], a[52:55], v[80:83], v[36:39]
  buffer_load_dwordx4 v26, s[28:31], 0 offen lds
  v_mfma_f32_16x16x32_bf16 v[36:39], a[48:51], v[132:135], v[36:39]
  ds_read_b128 a[44:47], v235 offset:32
  v_perm_b32 v128, v28, v96, v4
  v_mfma_f32_16x16x32_bf16 v[40:43], a[48:51], v[136:139], v[40:43]
  v_perm_b32 v96, v29, v97, v4
  v_perm_b32 v129, v30, v100, v4
  v_mfma_f32_16x16x32_bf16 v[40:43], a[52:55], v[84:87], v[40:43]
  v_perm_b32 v100, v31, v98, v4
  v_add_u32_dpp v27, v24, v23 row_newbcast:11 row_mask:0xf bank_mask:0xf
  v_mfma_f32_16x16x32_bf16 v[44:47], a[52:55], v[88:91], v[44:47]
  buffer_load_dwordx4 v[148:151], v2, s[36:39], s50 offen offset:2048
  v_mfma_f32_16x16x32_bf16 v[44:47], a[48:51], v[140:143], v[44:47]
  s_waitcnt vmcnt(14) lgkmcnt(4)
  ds_read_b128 a[52:55], v236 offset:32
  v_add_u32_sdwa v236, v228, v5 dst_sel:DWORD dst_unused:UNUSED_PAD src0_sel:WORD_1 src1_sel:DWORD
  v_mfma_f32_16x16x32_bf16 v[60:63], a[60:63], v[140:143], v[60:63]
  v_mov_b32_dpp v28, v101 row_ror:8 row_mask:0xf bank_mask:0xf
  v_mov_b32_dpp v29, v102 row_ror:8 row_mask:0xf bank_mask:0xf
  v_mfma_f32_16x16x32_bf16 v[60:63], a[56:59], v[88:91], v[60:63]
  s_add_u32 m0, s5, 11264
  v_mov_b32_dpp v30, v104 row_ror:8 row_mask:0xf bank_mask:0xf
  v_mov_b32_dpp v31, v99 row_ror:8 row_mask:0xf bank_mask:0xf
  v_mfma_f32_16x16x32_bf16 v[56:59], a[56:59], v[84:87], v[56:59]
  buffer_load_dwordx4 v27, s[28:31], 0 offen lds
  v_mfma_f32_16x16x32_bf16 v[56:59], a[60:63], v[136:139], v[56:59]
  ds_read_b128 a[48:51], v236
  v_perm_b32 v97, v28, v101, v4
  v_mfma_f32_16x16x32_bf16 v[52:55], a[60:63], v[132:135], v[52:55]
  v_perm_b32 v101, v29, v102, v4
  v_perm_b32 v130, v30, v104, v4
  v_mfma_f32_16x16x32_bf16 v[52:55], a[56:59], v[80:83], v[52:55]
  ds_read_b32 v228, v250 offset:128
  v_perm_b32 v104, v31, v99, v4
  v_mfma_f32_16x16x32_bf16 v[48:51], a[56:59], v[156:159], v[48:51]
  buffer_load_dwordx4 v[152:155], v3, s[36:39], s50 offen
  v_mfma_f32_16x16x32_bf16 v[48:51], a[60:63], v[76:79], v[48:51]
  s_waitcnt lgkmcnt(5)
  ds_read_b128 a[56:59], v237 offset:32
  v_add_u32_sdwa v237, v229, v5 dst_sel:DWORD dst_unused:UNUSED_PAD src0_sel:WORD_1 src1_sel:DWORD
  v_mfma_f32_16x16x32_bf16 v[160:163], a[36:39], v[76:79], v[160:163]
  v_mov_b32_dpp v28, v105 row_ror:8 row_mask:0xf bank_mask:0xf
  v_mov_b32_dpp v29, v103 row_ror:8 row_mask:0xf bank_mask:0xf
  v_mfma_f32_16x16x32_bf16 v[160:163], a[32:35], v[156:159], v[160:163]
  s_add_u32 m0, s56, 8192
  v_mov_b32_dpp v30, v106 row_ror:8 row_mask:0xf bank_mask:0xf
  v_mov_b32_dpp v31, v107 row_ror:8 row_mask:0xf bank_mask:0xf
  v_mfma_f32_16x16x32_bf16 v[164:167], a[32:35], v[80:83], v[164:167]
  s_mov_b32 s4, 8192
  buffer_load_dwordx4 v8, s[32:35], s4 offen lds
  v_mfma_f32_16x16x32_bf16 v[164:167], a[36:39], v[132:135], v[164:167]
  ds_read_b128 a[60:63], v237
  v_perm_b32 v98, v28, v105, v4
  v_mfma_f32_16x16x32_bf16 v[168:171], a[36:39], v[136:139], v[168:171]
  v_perm_b32 v105, v29, v103, v4
  v_perm_b32 v102, v30, v106, v4
  v_mfma_f32_16x16x32_bf16 v[168:171], a[32:35], v[84:87], v[168:171]
  ds_read_b32 v229, v250 offset:3328
  v_perm_b32 v106, v31, v107, v4
  v_mfma_f32_16x16x32_bf16 v[172:175], a[32:35], v[88:91], v[172:175]
  buffer_load_dwordx4 v[124:127], v3, s[36:39], s50 offen offset:2048
  v_mfma_f32_16x16x32_bf16 v[172:175], a[36:39], v[140:143], v[172:175]
  s_waitcnt vmcnt(17) lgkmcnt(6)
  ds_read_b128 a[32:35], v238 offset:32
  v_add_u32_sdwa v238, v230, v5 dst_sel:DWORD dst_unused:UNUSED_PAD src0_sel:WORD_1 src1_sel:DWORD
  v_mfma_f32_16x16x32_bf16 v[188:191], a[40:43], v[140:143], v[188:191]
  s_add_u32 s50, s50, 2097152
  v_mov_b32_dpp v28, v16 row_ror:8 row_mask:0xf bank_mask:0xf
  v_mov_b32_dpp v29, v17 row_ror:8 row_mask:0xf bank_mask:0xf
  v_mfma_f32_16x16x32_bf16 v[188:191], a[44:47], v[88:91], v[188:191]
  v_mov_b32_dpp v30, v18 row_ror:8 row_mask:0xf bank_mask:0xf
  v_mov_b32_dpp v31, v19 row_ror:8 row_mask:0xf bank_mask:0xf
  v_mfma_f32_16x16x32_bf16 v[184:187], a[44:47], v[84:87], v[184:187]
  buffer_load_dword v9, v6, s[36:39], s54 offen
  v_mfma_f32_16x16x32_bf16 v[184:187], a[40:43], v[136:139], v[184:187]
  s_add_u32 s54, s54, 2097152
  ds_read_b128 a[36:39], v238
  v_perm_b32 v131, v28, v16, v4
  v_mfma_f32_16x16x32_bf16 v[180:183], a[40:43], v[132:135], v[180:183]
  v_perm_b32 v99, v29, v17, v4
  v_perm_b32 v103, v30, v18, v4
  v_mfma_f32_16x16x32_bf16 v[180:183], a[44:47], v[80:83], v[180:183]
  ds_read_b32 v230, v251 offset:128
  v_perm_b32 v107, v31, v19, v4
  v_mfma_f32_16x16x32_bf16 v[176:179], a[44:47], v[156:159], v[176:179]
  buffer_load_dwordx4 v[140:143], v2, s[36:39], s51 offen
  v_mfma_f32_16x16x32_bf16 v[176:179], a[40:43], v[76:79], v[176:179]
  s_waitcnt vmcnt(17) lgkmcnt(7)
  ds_read_b128 a[44:47], v239 offset:32
  v_add_u32_sdwa v239, v231, v5 dst_sel:DWORD dst_unused:UNUSED_PAD src0_sel:WORD_1 src1_sel:DWORD
  v_mfma_f32_16x16x32_bf16 v[192:195], a[52:55], v[156:159], v[192:195]
  v_mov_b32_dpp v28, v112 row_ror:8 row_mask:0xf bank_mask:0xf
  v_mov_b32_dpp v29, v113 row_ror:8 row_mask:0xf bank_mask:0xf
  v_mfma_f32_16x16x32_bf16 v[192:195], a[48:51], v[128:131], v[192:195]
  v_mov_b32_dpp v30, v116 row_ror:8 row_mask:0xf bank_mask:0xf
  v_mov_b32_dpp v31, v114 row_ror:8 row_mask:0xf bank_mask:0xf
  v_mfma_f32_16x16x32_bf16 v[196:199], a[48:51], v[96:99], v[196:199]
  ds_read_b128 a[76:79], v240
  v_mfma_f32_16x16x32_bf16 v[196:199], a[52:55], v[80:83], v[196:199]
  ds_read_b128 a[40:43], v239
  v_perm_b32 v16, v28, v112, v4
  v_mfma_f32_16x16x32_bf16 v[200:203], a[52:55], v[84:87], v[200:203]
  v_perm_b32 v112, v29, v113, v4
  v_perm_b32 v17, v30, v116, v4
  v_mfma_f32_16x16x32_bf16 v[200:203], a[48:51], v[100:103], v[200:203]
  v_perm_b32 v116, v31, v114, v4
  v_add_u32_sdwa v232, v224, v5 dst_sel:DWORD dst_unused:UNUSED_PAD src0_sel:WORD_1 src1_sel:DWORD
  v_mfma_f32_16x16x32_bf16 v[204:207], a[48:51], v[104:107], v[204:207]
  buffer_load_dwordx4 v[136:139], v2, s[36:39], s51 offen offset:2048
  v_mfma_f32_16x16x32_bf16 v[204:207], a[52:55], v[88:91], v[204:207]
  s_waitcnt vmcnt(17) lgkmcnt(7)
  ds_read_b128 a[48:51], v232
  v_add_u32_sdwa v233, v225, v5 dst_sel:DWORD dst_unused:UNUSED_PAD src0_sel:WORD_1 src1_sel:DWORD
  v_mfma_f32_16x16x32_bf16 v[220:223], a[56:59], v[88:91], v[220:223]
  v_mov_b32_dpp v28, v117 row_ror:8 row_mask:0xf bank_mask:0xf
  v_mov_b32_dpp v29, v118 row_ror:8 row_mask:0xf bank_mask:0xf
  v_mfma_f32_16x16x32_bf16 v[220:223], a[60:63], v[104:107], v[220:223]
  v_mov_b32_dpp v30, v120 row_ror:8 row_mask:0xf bank_mask:0xf
  v_mov_b32_dpp v31, v115 row_ror:8 row_mask:0xf bank_mask:0xf
  v_mfma_f32_16x16x32_bf16 v[216:219], a[60:63], v[100:103], v[216:219]
  buffer_store_dwordx4 a[248:251], v8, s[40:43], s63 offen sc1
  v_mfma_f32_16x16x32_bf16 v[216:219], a[56:59], v[84:87], v[216:219]
  s_xor_b32 s63, s63, 12288
  ds_read_b128 a[52:55], v232 offset:32
  v_perm_b32 v113, v28, v117, v4
  v_mfma_f32_16x16x32_bf16 v[212:215], a[56:59], v[80:83], v[212:215]
  v_perm_b32 v117, v29, v118, v4
  v_perm_b32 v18, v30, v120, v4
  v_mfma_f32_16x16x32_bf16 v[212:215], a[60:63], v[96:99], v[212:215]
  ds_read_b32 v231, v251 offset:3328
  v_perm_b32 v120, v31, v115, v4
  v_mfma_f32_16x16x32_bf16 v[208:211], a[60:63], v[128:131], v[208:211]
  buffer_load_dwordx4 v[132:135], v3, s[36:39], s51 offen
  v_mfma_f32_16x16x32_bf16 v[208:211], a[56:59], v[156:159], v[208:211]
  s_waitcnt lgkmcnt(7)
  ds_read_b128 a[60:63], v233
  v_add_u32_sdwa v234, v226, v5 dst_sel:DWORD dst_unused:UNUSED_PAD src0_sel:WORD_1 src1_sel:DWORD
  v_mfma_f32_16x16x32_bf16 a[0:3], a[32:35], v[156:159], a[0:3]
  v_mov_b32_dpp v28, v121 row_ror:8 row_mask:0xf bank_mask:0xf
  v_mov_b32_dpp v29, v119 row_ror:8 row_mask:0xf bank_mask:0xf
  v_mfma_f32_16x16x32_bf16 a[0:3], a[36:39], v[128:131], a[0:3]
  v_mov_b32_dpp v30, v122 row_ror:8 row_mask:0xf bank_mask:0xf
  v_mov_b32_dpp v31, v123 row_ror:8 row_mask:0xf bank_mask:0xf
  v_mfma_f32_16x16x32_bf16 a[4:7], a[36:39], v[96:99], a[4:7]
  ds_read_b32 v224, v248 offset:128
  v_cmp_eq_u32 vcc, 0, v12
  v_mfma_f32_16x16x32_bf16 a[4:7], a[32:35], v[80:83], a[4:7]
  ds_read_b128 a[56:59], v233 offset:32
  v_perm_b32 v114, v28, v121, v4
  v_mfma_f32_16x16x32_bf16 a[8:11], a[32:35], v[84:87], a[8:11]
  v_perm_b32 v121, v29, v119, v4
  v_perm_b32 v118, v30, v122, v4
  v_mfma_f32_16x16x32_bf16 a[8:11], a[36:39], v[100:103], a[8:11]
  s_cbranch_vccnz Ltag
Ltagok:
  ds_read_b32 v225, v248 offset:3328
  v_perm_b32 v122, v31, v123, v4
  v_mfma_f32_16x16x32_bf16 a[12:15], a[36:39], v[104:107], a[12:15]
  buffer_load_dwordx4 v[76:79], v3, s[36:39], s51 offen offset:2048
  v_mfma_f32_16x16x32_bf16 a[12:15], a[32:35], v[88:91], a[12:15]
  s_waitcnt vmcnt(19) lgkmcnt(7)
  ds_read_b128 a[36:39], v234
  v_add_u32_sdwa v235, v227, v5 dst_sel:DWORD dst_unused:UNUSED_PAD src0_sel:WORD_1 src1_sel:DWORD
  v_mfma_f32_16x16x32_bf16 a[28:31], a[44:47], v[88:91], a[28:31]
  s_add_u32 s51, s51, 2097152
  v_mov_b32_dpp v28, v92 row_ror:8 row_mask:0xf bank_mask:0xf
  v_mov_b32_dpp v29, v93 row_ror:8 row_mask:0xf bank_mask:0xf
  v_mfma_f32_16x16x32_bf16 a[28:31], a[40:43], v[104:107], a[28:31]
  v_mov_b32_dpp v30, v94 row_ror:8 row_mask:0xf bank_mask:0xf
  v_mov_b32_dpp v31, v95 row_ror:8 row_mask:0xf bank_mask:0xf
  v_mfma_f32_16x16x32_bf16 a[24:27], a[40:43], v[100:103], a[24:27]
  ds_read_b128 a[92:95], v241
  v_mfma_f32_16x16x32_bf16 a[24:27], a[44:47], v[84:87], a[24:27]
  ds_read_b128 a[32:35], v234 offset:32
  v_perm_b32 v19, v28, v92, v4
  v_mfma_f32_16x16x32_bf16 a[20:23], a[44:47], v[80:83], a[20:23]
  v_perm_b32 v115, v29, v93, v4
  v_perm_b32 v119, v30, v94, v4
  v_mfma_f32_16x16x32_bf16 a[20:23], a[40:43], v[96:99], a[20:23]
  ds_read_b32 v226, v249 offset:128
  v_perm_b32 v123, v31, v95, v4
  v_mfma_f32_16x16x32_bf16 a[16:19], a[40:43], v[128:131], a[16:19]
  buffer_load_dwordx4 v[88:91], v2, s[36:39], s52 offen
  v_mfma_f32_16x16x32_bf16 a[16:19], a[44:47], v[156:159], a[16:19]
  s_waitcnt vmcnt(18) lgkmcnt(9)
  ds_read_b128 a[40:43], v235
  v_mfma_f32_16x16x32_bf16 v[32:35], a[48:51], v[128:131], v[32:35]
  v_mov_b32_dpp v28, v64 row_ror:8 row_mask:0xf bank_mask:0xf
  v_mov_b32_dpp v29, v65 row_ror:8 row_mask:0xf bank_mask:0xf
  v_mfma_f32_16x16x32_bf16 v[32:35], a[52:55], v[16:19], v[32:35]
  v_mov_b32_dpp v30, v68 row_ror:8 row_mask:0xf bank_mask:0xf
  v_mov_b32_dpp v31, v66 row_ror:8 row_mask:0xf bank_mask:0xf
  v_mfma_f32_16x16x32_bf16 v[36:39], a[52:55], v[112:115], v[36:39]
  ds_read_b128 a[108:111], v242
  v_mfma_f32_16x16x32_bf16 v[36:39], a[48:51], v[96:99], v[36:39]
  ds_read_b128 a[44:47], v235 offset:32
  v_perm_b32 v92, v28, v64, v4
  v_mfma_f32_16x16x32_bf16 v[40:43], a[48:51], v[100:103], v[40:43]
  v_perm_b32 v64, v29, v65, v4
  v_perm_b32 v93, v30, v68, v4
  v_mfma_f32_16x16x32_bf16 v[40:43], a[52:55], v[116:119], v[40:43]
  ds_read_b32 v227, v249 offset:3328
  v_perm_b32 v68, v31, v66, v4
  v_mfma_f32_16x16x32_bf16 v[44:47], a[52:55], v[120:123], v[44:47]
  buffer_load_dwordx4 v[84:87], v2, s[36:39], s52 offen offset:2048
  v_mfma_f32_16x16x32_bf16 v[44:47], a[48:51], v[104:107], v[44:47]
  s_waitcnt vmcnt(18) lgkmcnt(9)
  ds_read_b128 a[52:55], v236 offset:32
  v_add_u32_sdwa v236, v228, v5 dst_sel:DWORD dst_unused:UNUSED_PAD src0_sel:WORD_0 src1_sel:DWORD
  v_mfma_f32_16x16x32_bf16 v[60:63], a[60:63], v[104:107], v[60:63]
  v_mov_b32_dpp v28, v69 row_ror:8 row_mask:0xf bank_mask:0xf
  v_mov_b32_dpp v29, v70 row_ror:8 row_mask:0xf bank_mask:0xf
  v_mfma_f32_16x16x32_bf16 v[60:63], a[56:59], v[120:123], v[60:63]
  v_mov_b32_dpp v30, v72 row_ror:8 row_mask:0xf bank_mask:0xf
  v_mov_b32_dpp v31, v67 row_ror:8 row_mask:0xf bank_mask:0xf
  v_mfma_f32_16x16x32_bf16 v[56:59], a[56:59], v[116:119], v[56:59]
  ds_read_b128 a[124:127], v243
  v_mfma_f32_16x16x32_bf16 v[56:59], a[60:63], v[100:103], v[56:59]
  ds_read_b128 a[48:51], v236
  v_perm_b32 v65, v28, v69, v4
  v_mfma_f32_16x16x32_bf16 v[52:55], a[60:63], v[96:99], v[52:55]
  v_perm_b32 v69, v29, v70, v4
  v_perm_b32 v94, v30, v72, v4
  v_mfma_f32_16x16x32_bf16 v[52:55], a[56:59], v[112:115], v[52:55]
  v_perm_b32 v72, v31, v67, v4
  v_mfma_f32_16x16x32_bf16 v[48:51], a[56:59], v[16:19], v[48:51]
  s_waitcnt vmcnt(11)
  buffer_load_dwordx4 v[80:83], v3, s[36:39], s52 offen
  v_mfma_f32_16x16x32_bf16 v[48:51], a[60:63], v[128:131], v[48:51]
  s_waitcnt lgkmcnt(8)
  ds_read_b128 a[56:59], v237 offset:32
  v_add_u32_sdwa v237, v229, v5 dst_sel:DWORD dst_unused:UNUSED_PAD src0_sel:WORD_0 src1_sel:DWORD
  v_mfma_f32_16x16x32_bf16 v[160:163], a[36:39], v[128:131], v[160:163]
  v_mov_b32_dpp v28, v73 row_ror:8 row_mask:0xf bank_mask:0xf
  v_mov_b32_dpp v29, v71 row_ror:8 row_mask:0xf bank_mask:0xf
  v_mfma_f32_16x16x32_bf16 v[160:163], a[32:35], v[16:19], v[160:163]
  v_mov_b32_dpp v30, v74 row_ror:8 row_mask:0xf bank_mask:0xf
  v_mov_b32_dpp v31, v75 row_ror:8 row_mask:0xf bank_mask:0xf
  v_mfma_f32_16x16x32_bf16 v[164:167], a[32:35], v[112:115], v[164:167]
  ds_read_b128 a[160:163], v0 offset:8192
  v_mfma_f32_16x16x32_bf16 v[164:167], a[36:39], v[96:99], v[164:167]
  ds_read_b128 a[60:63], v237
  v_perm_b32 v66, v28, v73, v4
  v_mfma_f32_16x16x32_bf16 v[168:171], a[36:39], v[100:103], v[168:171]
  v_perm_b32 v73, v29, v71, v4
  v_perm_b32 v70, v30, v74, v4
  v_mfma_f32_16x16x32_bf16 v[168:171], a[32:35], v[116:119], v[168:171]
  v_perm_b32 v74, v31, v75, v4
  v_mfma_f32_16x16x32_bf16 v[172:175], a[32:35], v[120:123], v[172:175]
  buffer_load_dwordx4 v[156:159], v3, s[36:39], s52 offen offset:2048
  v_mfma_f32_16x16x32_bf16 v[172:175], a[36:39], v[104:107], v[172:175]
  s_waitcnt lgkmcnt(7)
  ds_read_b128 a[32:35], v238 offset:32
  v_add_u32_sdwa v238, v230, v5 dst_sel:DWORD dst_unused:UNUSED_PAD src0_sel:WORD_0 src1_sel:DWORD
  v_mfma_f32_16x16x32_bf16 v[188:191], a[40:43], v[104:107], v[188:191]
  s_add_u32 s52, s52, 2097152
  v_mov_b32_dpp v28, v108 row_ror:8 row_mask:0xf bank_mask:0xf
  v_mov_b32_dpp v29, v109 row_ror:8 row_mask:0xf bank_mask:0xf
  v_mfma_f32_16x16x32_bf16 v[188:191], a[44:47], v[120:123], v[188:191]
  v_mov_b32_dpp v30, v110 row_ror:8 row_mask:0xf bank_mask:0xf
  v_mov_b32_dpp v31, v111 row_ror:8 row_mask:0xf bank_mask:0xf
  v_mfma_f32_16x16x32_bf16 v[184:187], a[44:47], v[116:119], v[184:187]
  ds_read_b128 a[164:167], v253 offset:8192
  v_mfma_f32_16x16x32_bf16 v[184:187], a[40:43], v[100:103], v[184:187]
  ds_read_b128 a[36:39], v238
  v_perm_b32 v95, v28, v108, v4
  v_mfma_f32_16x16x32_bf16 v[180:183], a[40:43], v[96:99], v[180:183]
  v_perm_b32 v67, v29, v109, v4
  v_perm_b32 v71, v30, v110, v4
  v_mfma_f32_16x16x32_bf16 v[180:183], a[44:47], v[112:115], v[180:183]
  v_perm_b32 v75, v31, v111, v4
  v_add_u32_dpp v26, v24, v20 row_newbcast:12 row_mask:0xf bank_mask:0xf
  v_mfma_f32_16x16x32_bf16 v[176:179], a[44:47], v[16:19], v[176:179]
  buffer_load_dwordx4 v[104:107], v2, s[36:39], s53 offen
  v_mfma_f32_16x16x32_bf16 v[176:179], a[40:43], v[128:131], v[176:179]
  s_waitcnt lgkmcnt(6)
  ds_read_b128 a[44:47], v239 offset:32
  v_add_u32_sdwa v239, v231, v5 dst_sel:DWORD dst_unused:UNUSED_PAD src0_sel:WORD_0 src1_sel:DWORD
  v_mfma_f32_16x16x32_bf16 v[192:195], a[52:55], v[16:19], v[192:195]
  v_mov_b32_dpp v28, v144 row_ror:8 row_mask:0xf bank_mask:0xf
  v_mov_b32_dpp v29, v145 row_ror:8 row_mask:0xf bank_mask:0xf
  v_mfma_f32_16x16x32_bf16 v[192:195], a[48:51], v[92:95], v[192:195]
  v_mov_b32_dpp v30, v148 row_ror:8 row_mask:0xf bank_mask:0xf
  v_mov_b32_dpp v31, v146 row_ror:8 row_mask:0xf bank_mask:0xf
  v_mfma_f32_16x16x32_bf16 v[196:199], a[48:51], v[64:67], v[196:199]
  ds_read_b128 a[168:171], v254 offset:8192
  v_mfma_f32_16x16x32_bf16 v[196:199], a[52:55], v[112:115], v[196:199]
  ds_read_b128 a[40:43], v239
  v_perm_b32 v108, v28, v144, v4
  v_mfma_f32_16x16x32_bf16 v[200:203], a[52:55], v[116:119], v[200:203]
  v_perm_b32 v144, v29, v145, v4
  v_perm_b32 v109, v30, v148, v4
  v_mfma_f32_16x16x32_bf16 v[200:203], a[48:51], v[68:71], v[200:203]
  v_perm_b32 v148, v31, v146, v4
  v_add_u32_sdwa v232, v224, v5 dst_sel:DWORD dst_unused:UNUSED_PAD src0_sel:WORD_0 src1_sel:DWORD
  v_mfma_f32_16x16x32_bf16 v[204:207], a[48:51], v[72:75], v[204:207]
  buffer_load_dwordx4 v[100:103], v2, s[36:39], s53 offen offset:2048
  v_mfma_f32_16x16x32_bf16 v[204:207], a[52:55], v[120:123], v[204:207]
  s_waitcnt vmcnt(14) lgkmcnt(6)
  ds_read_b128 a[48:51], v232
  v_add_u32_sdwa v233, v225, v5 dst_sel:DWORD dst_unused:UNUSED_PAD src0_sel:WORD_0 src1_sel:DWORD
  v_mfma_f32_16x16x32_bf16 v[220:223], a[56:59], v[120:123], v[220:223]
  v_mov_b32_dpp v28, v149 row_ror:8 row_mask:0xf bank_mask:0xf
  v_mov_b32_dpp v29, v150 row_ror:8 row_mask:0xf bank_mask:0xf
  v_mfma_f32_16x16x32_bf16 v[220:223], a[60:63], v[72:75], v[220:223]
  s_add_u32 m0, s5, 4096
  v_mov_b32_dpp v30, v152 row_ror:8 row_mask:0xf bank_mask:0xf
  v_mov_b32_dpp v31, v147 row_ror:8 row_mask:0xf bank_mask:0xf
  v_mfma_f32_16x16x32_bf16 v[216:219], a[60:63], v[68:71], v[216:219]
  buffer_load_dwordx4 v26, s[28:31], 0 offen lds
  v_mfma_f32_16x16x32_bf16 v[216:219], a[56:59], v[116:119], v[216:219]
  ds_read_b128 a[52:55], v232 offset:32
  v_perm_b32 v145, v28, v149, v4
  v_mfma_f32_16x16x32_bf16 v[212:215], a[56:59], v[112:115], v[212:215]
  v_perm_b32 v149, v29, v150, v4
  v_perm_b32 v110, v30, v152, v4
  v_mfma_f32_16x16x32_bf16 v[212:215], a[60:63], v[64:67], v[212:215]
  v_perm_b32 v152, v31, v147, v4
  v_add_u32_dpp v27, v24, v21 row_newbcast:13 row_mask:0xf bank_mask:0xf
  v_mfma_f32_16x16x32_bf16 v[208:211], a[60:63], v[92:95], v[208:211]
  buffer_load_dwordx4 v[96:99], v3, s[36:39], s53 offen
  v_mfma_f32_16x16x32_bf16 v[208:211], a[56:59], v[16:19], v[208:211]
  s_waitcnt lgkmcnt(5)
  ds_read_b128 a[60:63], v233
  v_add_u32_sdwa v234, v226, v5 dst_sel:DWORD dst_unused:UNUSED_PAD src0_sel:WORD_0 src1_sel:DWORD
  v_mfma_f32_16x16x32_bf16 a[0:3], a[32:35], v[16:19], a[0:3]
Lst3:
  s_cbranch_execz Lret
  v_mov_b32_dpp v28, v153 row_ror:8 row_mask:0xf bank_mask:0xf
  v_mov_b32_dpp v29, v151 row_ror:8 row_mask:0xf bank_mask:0xf
  v_mfma_f32_16x16x32_bf16 a[0:3], a[36:39], v[92:95], a[0:3]
  s_add_u32 m0, s5, 5120
  v_mov_b32_dpp v30, v154 row_ror:8 row_mask:0xf bank_mask:0xf
  v_mov_b32_dpp v31, v155 row_ror:8 row_mask:0xf bank_mask:0xf
  v_mfma_f32_16x16x32_bf16 a[4:7], a[36:39], v[64:67], a[4:7]
  buffer_load_dwordx4 v27, s[28:31], 0 offen lds
  v_mfma_f32_16x16x32_bf16 a[4:7], a[32:35], v[112:115], a[4:7]
  ds_read_b128 a[56:59], v233 offset:32
  v_perm_b32 v146, v28, v153, v4
  v_mfma_f32_16x16x32_bf16 a[8:11], a[32:35], v[116:119], a[8:11]
  v_perm_b32 v153, v29, v151, v4
  v_perm_b32 v150, v30, v154, v4
  v_mfma_f32_16x16x32_bf16 a[8:11], a[36:39], v[68:71], a[8:11]
  v_perm_b32 v154, v31, v155, v4
  v_add_u32_dpp v26, v24, v22 row_newbcast:14 row_mask:0xf bank_mask:0xf
  v_mfma_f32_16x16x32_bf16 a[12:15], a[36:39], v[72:75], a[12:15]
  buffer_load_dwordx4 v[128:131], v3, s[36:39], s53 offen offset:2048
  v_mfma_f32_16x16x32_bf16 a[12:15], a[32:35], v[120:123], a[12:15]
  s_waitcnt vmcnt(16) lgkmcnt(4)
  ds_read_b128 a[36:39], v234
  v_add_u32_sdwa v235, v227, v5 dst_sel:DWORD dst_unused:UNUSED_PAD src0_sel:WORD_0 src1_sel:DWORD
  v_mfma_f32_16x16x32_bf16 a[28:31], a[44:47], v[120:123], a[28:31]
  v_mov_b32_dpp v28, v124 row_ror:8 row_mask:0xf bank_mask:0xf
  v_mov_b32_dpp v29, v125 row_ror:8 row_mask:0xf bank_mask:0xf
  v_mfma_f32_16x16x32_bf16 a[28:31], a[40:43], v[72:75], a[28:31]
  s_add_u32 m0, s5, 6144
  v_mov_b32_dpp v30, v126 row_ror:8 row_mask:0xf bank_mask:0xf
  v_mov_b32_dpp v31, v127 row_ror:8 row_mask:0xf bank_mask:0xf
  v_mfma_f32_16x16x32_bf16 a[24:27], a[40:43], v[68:71], a[24:27]
  buffer_load_dwordx4 v26, s[28:31], 0 offen lds
  v_mfma_f32_16x16x32_bf16 a[24:27], a[44:47], v[116:119], a[24:27]
  ds_read_b128 a[32:35], v234 offset:32
  v_perm_b32 v111, v28, v124, v4
  v_mfma_f32_16x16x32_bf16 a[20:23], a[44:47], v[112:115], a[20:23]
  v_perm_b32 v147, v29, v125, v4
  v_perm_b32 v151, v30, v126, v4
  v_mfma_f32_16x16x32_bf16 a[20:23], a[40:43], v[64:67], a[20:23]
  ds_read_b128 a[172:175], v255 offset:8192
  v_perm_b32 v155, v31, v127, v4
  v_mfma_f32_16x16x32_bf16 a[16:19], a[40:43], v[92:95], a[16:19]
  buffer_load_dwordx4 v[120:123], v2, s[36:39], s50 offen
  v_mfma_f32_16x16x32_bf16 a[16:19], a[44:47], v[16:19], a[16:19]
  s_waitcnt vmcnt(15) lgkmcnt(5)
  ds_read_b128 a[40:43], v235
  v_add_u32_dpp v27, v24, v23 row_newbcast:15 row_mask:0xf bank_mask:0xf
  v_mfma_f32_16x16x32_bf16 v[32:35], a[48:51], v[92:95], v[32:35]
  v_mov_b32_dpp v28, v140 row_ror:8 row_mask:0xf bank_mask:0xf
  v_mov_b32_dpp v29, v141 row_ror:8 row_mask:0xf bank_mask:0xf
  v_mfma_f32_16x16x32_bf16 v[32:35], a[52:55], v[108:111], v[32:35]
  s_add_u32 m0, s5, 7168
  v_mov_b32_dpp v30, v136 row_ror:8 row_mask:0xf bank_mask:0xf
  v_mov_b32_dpp v31, v142 row_ror:8 row_mask:0xf bank_mask:0xf
  v_mfma_f32_16x16x32_bf16 v[36:39], a[52:55], v[144:147], v[36:39]
  buffer_load_dwordx4 v27, s[28:31], 0 offen lds
  v_mfma_f32_16x16x32_bf16 v[36:39], a[48:51], v[64:67], v[36:39]
  ds_read_b128 a[44:47], v235 offset:32
  v_perm_b32 v124, v28, v140, v4
  v_mfma_f32_16x16x32_bf16 v[40:43], a[48:51], v[68:71], v[40:43]
  v_perm_b32 v140, v29, v141, v4
  v_perm_b32 v125, v30, v136, v4
  v_mfma_f32_16x16x32_bf16 v[40:43], a[52:55], v[148:151], v[40:43]
  v_perm_b32 v136, v31, v142, v4
  v_mfma_f32_16x16x32_bf16 v[44:47], a[52:55], v[152:155], v[44:47]
  buffer_load_dwordx4 v[116:119], v2, s[36:39], s50 offen offset:2048
  v_mfma_f32_16x16x32_bf16 v[44:47], a[48:51], v[72:75], v[44:47]
  s_waitcnt vmcnt(15) lgkmcnt(5)
  ds_read_b128 a[52:55], v236 offset:32
  v_add_u32_sdwa v236, v228, v5 dst_sel:DWORD dst_unused:UNUSED_PAD src0_sel:WORD_1 src1_sel:DWORD
  v_mfma_f32_16x16x32_bf16 v[60:63], a[60:63], v[72:75], v[60:63]
  v_mov_b32_dpp v28, v137 row_ror:8 row_mask:0xf bank_mask:0xf
  v_mov_b32_dpp v29, v138 row_ror:8 row_mask:0xf bank_mask:0xf
  v_mfma_f32_16x16x32_bf16 v[60:63], a[56:59], v[152:155], v[60:63]
  s_add_u32 m0, s56, 12288
  v_mov_b32_dpp v30, v132 row_ror:8 row_mask:0xf bank_mask:0xf
  v_mov_b32_dpp v31, v143 row_ror:8 row_mask:0xf bank_mask:0xf
  v_mfma_f32_16x16x32_bf16 v[56:59], a[56:59], v[148:151], v[56:59]
  s_mov_b32 s4, 12288
  buffer_load_dwordx4 v8, s[32:35], s4 offen lds
  v_mfma_f32_16x16x32_bf16 v[56:59], a[60:63], v[68:71], v[56:59]
  ds_read_b128 a[48:51], v236
  v_perm_b32 v141, v28, v137, v4
  v_mfma_f32_16x16x32_bf16 v[52:55], a[60:63], v[64:67], v[52:55]
  v_perm_b32 v137, v29, v138, v4
  v_perm_b32 v126, v30, v132, v4
  v_mfma_f32_16x16x32_bf16 v[52:55], a[56:59], v[144:147], v[52:55]
  ds_read_b32 v228, v250 offset:160
  v_perm_b32 v132, v31, v143, v4
  v_mfma_f32_16x16x32_bf16 v[48:51], a[56:59], v[108:111], v[48:51]
  buffer_load_dwordx4 v[112:115], v3, s[36:39], s50 offen
  v_mfma_f32_16x16x32_bf16 v[48:51], a[60:63], v[92:95], v[48:51]
  s_waitcnt lgkmcnt(6)
  ds_read_b128 a[56:59], v237 offset:32
  v_add_u32_sdwa v237, v229, v5 dst_sel:DWORD dst_unused:UNUSED_PAD src0_sel:WORD_1 src1_sel:DWORD
  v_mfma_f32_16x16x32_bf16 v[160:163], a[36:39], v[92:95], v[160:163]
  v_mov_b32_dpp v28, v133 row_ror:8 row_mask:0xf bank_mask:0xf
  v_mov_b32_dpp v29, v139 row_ror:8 row_mask:0xf bank_mask:0xf
  v_mfma_f32_16x16x32_bf16 v[160:163], a[32:35], v[108:111], v[160:163]
  s_add_u32 m0, s56, 16384
  v_mov_b32_dpp v30, v134 row_ror:8 row_mask:0xf bank_mask:0xf
  v_mov_b32_dpp v31, v135 row_ror:8 row_mask:0xf bank_mask:0xf
  v_mfma_f32_16x16x32_bf16 v[164:167], a[32:35], v[144:147], v[164:167]
  s_mov_b32 s4, 16384
  buffer_load_dwordx4 v8, s[32:35], s4 offen lds
  v_mfma_f32_16x16x32_bf16 v[164:167], a[36:39], v[64:67], v[164:167]
  ds_read_b128 a[60:63], v237
  v_perm_b32 v142, v28, v133, v4
  v_mfma_f32_16x16x32_bf16 v[168:171], a[36:39], v[68:71], v[168:171]
  v_perm_b32 v133, v29, v139, v4
  v_perm_b32 v138, v30, v134, v4
  v_mfma_f32_16x16x32_bf16 v[168:171], a[32:35], v[148:151], v[168:171]
  ds_read_b32 v229, v250 offset:3360
  v_perm_b32 v134, v31, v135, v4
  v_mfma_f32_16x16x32_bf16 v[172:175], a[32:35], v[152:155], v[172:175]
  buffer_load_dwordx4 v[16:19], v3, s[36:39], s50 offen offset:2048
  v_mfma_f32_16x16x32_bf16 v[172:175], a[36:39], v[72:75], v[172:175]
  s_waitcnt vmcnt(18) lgkmcnt(6)
  ds_read_b128 a[32:35], v238 offset:32
  v_add_u32_sdwa v238, v230, v5 dst_sel:DWORD dst_unused:UNUSED_PAD src0_sel:WORD_1 src1_sel:DWORD
  v_mfma_f32_16x16x32_bf16 v[188:191], a[40:43], v[72:75], v[188:191]
  v_mov_b32_dpp v28, v76 row_ror:8 row_mask:0xf bank_mask:0xf
  v_mov_b32_dpp v29, v77 row_ror:8 row_mask:0xf bank_mask:0xf
  v_mfma_f32_16x16x32_bf16 v[188:191], a[44:47], v[152:155], v[188:191]
  v_mov_b32_dpp v30, v78 row_ror:8 row_mask:0xf bank_mask:0xf
  v_mov_b32_dpp v31, v79 row_ror:8 row_mask:0xf bank_mask:0xf
  v_mfma_f32_16x16x32_bf16 v[184:187], a[44:47], v[148:151], v[184:187]
  buffer_load_dword v9, v6, s[36:39], s54 offen
  v_mfma_f32_16x16x32_bf16 v[184:187], a[40:43], v[68:71], v[184:187]
  s_add_u32 s54, s54, 2097152
  ds_read_b128 a[36:39], v238
  v_perm_b32 v127, v28, v76, v4
  v_mfma_f32_16x16x32_bf16 v[180:183], a[40:43], v[64:67], v[180:183]
  v_perm_b32 v143, v29, v77, v4
  v_perm_b32 v139, v30, v78, v4
  v_mfma_f32_16x16x32_bf16 v[180:183], a[44:47], v[144:147], v[180:183]
  ds_read_b32 v230, v251 offset:160
  v_perm_b32 v135, v31, v79, v4
  v_mfma_f32_16x16x32_bf16 v[176:179], a[44:47], v[108:111], v[176:179]
  buffer_load_dwordx4 v[72:75], v2, s[36:39], s51 offen
  v_mfma_f32_16x16x32_bf16 v[176:179], a[40:43], v[92:95], v[176:179]
  s_waitcnt vmcnt(18) lgkmcnt(7)
  ds_read_b128 a[44:47], v239 offset:32
  v_add_u32_sdwa v239, v231, v5 dst_sel:DWORD dst_unused:UNUSED_PAD src0_sel:WORD_1 src1_sel:DWORD
  v_mfma_f32_16x16x32_bf16 v[192:195], a[52:55], v[108:111], v[192:195]
  v_mov_b32_dpp v28, v88 row_ror:8 row_mask:0xf bank_mask:0xf
  v_mov_b32_dpp v29, v89 row_ror:8 row_mask:0xf bank_mask:0xf
  v_mfma_f32_16x16x32_bf16 v[192:195], a[48:51], v[124:127], v[192:195]
  s_mov_b32 m0, s57
  v_mov_b32_dpp v30, v84 row_ror:8 row_mask:0xf bank_mask:0xf
  v_mov_b32_dpp v31, v90 row_ror:8 row_mask:0xf bank_mask:0xf
  v_mfma_f32_16x16x32_bf16 v[196:199], a[48:51], v[140:143], v[196:199]
  s_mov_b32 s4, 20480
  buffer_load_dwordx4 v8, s[32:35], s4 offen lds
  v_mfma_f32_16x16x32_bf16 v[196:199], a[52:55], v[144:147], v[196:199]
  ds_read_b128 a[40:43], v239
  v_perm_b32 v76, v28, v88, v4
  v_mfma_f32_16x16x32_bf16 v[200:203], a[52:55], v[148:151], v[200:203]
  v_perm_b32 v88, v29, v89, v4
  v_perm_b32 v77, v30, v84, v4
  v_mfma_f32_16x16x32_bf16 v[200:203], a[48:51], v[136:139], v[200:203]
  v_perm_b32 v84, v31, v90, v4
  v_add_u32_sdwa v232, v224, v5 dst_sel:DWORD dst_unused:UNUSED_PAD src0_sel:WORD_1 src1_sel:DWORD
  v_mfma_f32_16x16x32_bf16 v[204:207], a[48:51], v[132:135], v[204:207]
  buffer_load_dwordx4 v[68:71], v2, s[36:39], s51 offen offset:2048
  v_mfma_f32_16x16x32_bf16 v[204:207], a[52:55], v[152:155], v[204:207]
  s_waitcnt vmcnt(19) lgkmcnt(6)
  ds_read_b128 a[48:51], v232
  v_add_u32_sdwa v233, v225, v5 dst_sel:DWORD dst_unused:UNUSED_PAD src0_sel:WORD_1 src1_sel:DWORD
  v_mfma_f32_16x16x32_bf16 v[220:223], a[56:59], v[152:155], v[220:223]
  v_mov_b32_dpp v28, v85 row_ror:8 row_mask:0xf bank_mask:0xf
  v_mov_b32_dpp v29, v86 row_ror:8 row_mask:0xf bank_mask:0xf
  v_mfma_f32_16x16x32_bf16 v[220:223], a[60:63], v[132:135], v[220:223]
  v_mov_b32_dpp v30, v80 row_ror:8 row_mask:0xf bank_mask:0xf
  v_mov_b32_dpp v31, v91 row_ror:8 row_mask:0xf bank_mask:0xf
  v_mfma_f32_16x16x32_bf16 v[216:219], a[60:63], v[136:139], v[216:219]
  buffer_store_dword v12, v11, s[40:43], 0 offen sc1
  v_mfma_f32_16x16x32_bf16 v[216:219], a[56:59], v[148:151], v[216:219]
  ds_read_b128 a[52:55], v232 offset:32
  v_perm_b32 v89, v28, v85, v4
  v_mfma_f32_16x16x32_bf16 v[212:215], a[56:59], v[144:147], v[212:215]
  v_perm_b32 v85, v29, v86, v4
  v_perm_b32 v78, v30, v80, v4
  v_mfma_f32_16x16x32_bf16 v[212:215], a[60:63], v[140:143], v[212:215]
  ds_read_b32 v224, v248 offset:160
  v_perm_b32 v80, v31, v91, v4
  v_mfma_f32_16x16x32_bf16 v[208:211], a[60:63], v[124:127], v[208:211]
  buffer_load_dwordx4 v[64:67], v3, s[36:39], s51 offen
  v_mfma_f32_16x16x32_bf16 v[208:211], a[56:59], v[108:111], v[208:211]
  s_waitcnt lgkmcnt(6)
  ds_read_b128 a[60:63], v233
  v_add_u32_sdwa v234, v226, v5 dst_sel:DWORD dst_unused:UNUSED_PAD src0_sel:WORD_1 src1_sel:DWORD
  v_mfma_f32_16x16x32_bf16 a[0:3], a[32:35], v[108:111], a[0:3]
  v_mov_b32_dpp v28, v81 row_ror:8 row_mask:0xf bank_mask:0xf
  v_mov_b32_dpp v29, v87 row_ror:8 row_mask:0xf bank_mask:0xf
  v_mfma_f32_16x16x32_bf16 a[0:3], a[36:39], v[124:127], a[0:3]
  v_mov_b32_dpp v30, v82 row_ror:8 row_mask:0xf bank_mask:0xf
  v_mov_b32_dpp v31, v83 row_ror:8 row_mask:0xf bank_mask:0xf
  v_mfma_f32_16x16x32_bf16 a[4:7], a[36:39], v[140:143], a[4:7]
  s_waitcnt vmcnt(11)
  ds_read_b32 v231, v251 offset:3360
  v_accvgpr_read_b32 v20, a252
  v_mfma_f32_16x16x32_bf16 a[4:7], a[32:35], v[144:147], a[4:7]
  ds_read_b128 a[56:59], v233 offset:32
  v_perm_b32 v90, v28, v81, v4
  v_mfma_f32_16x16x32_bf16 a[8:11], a[32:35], v[148:151], a[8:11]
  v_perm_b32 v81, v29, v87, v4
  v_perm_b32 v86, v30, v82, v4
  v_mfma_f32_16x16x32_bf16 a[8:11], a[36:39], v[136:139], a[8:11]
  ds_read_b32 v226, v249 offset:160
  v_perm_b32 v82, v31, v83, v4
  v_mfma_f32_16x16x32_bf16 a[12:15], a[36:39], v[132:135], a[12:15]
  buffer_load_dwordx4 v[92:95], v3, s[36:39], s51 offen offset:2048
  v_mfma_f32_16x16x32_bf16 a[12:15], a[32:35], v[152:155], a[12:15]
  s_waitcnt lgkmcnt(7)
  ds_read_b128 a[36:39], v234
  v_add_u32_sdwa v235, v227, v5 dst_sel:DWORD dst_unused:UNUSED_PAD src0_sel:WORD_1 src1_sel:DWORD
  v_mfma_f32_16x16x32_bf16 a[28:31], a[44:47], v[152:155], a[28:31]
  v_mov_b32_dpp v28, v156 row_ror:8 row_mask:0xf bank_mask:0xf
  v_mov_b32_dpp v29, v157 row_ror:8 row_mask:0xf bank_mask:0xf
  v_mfma_f32_16x16x32_bf16 a[28:31], a[40:43], v[132:135], a[28:31]
  v_mov_b32_dpp v30, v158 row_ror:8 row_mask:0xf bank_mask:0xf
  v_mov_b32_dpp v31, v159 row_ror:8 row_mask:0xf bank_mask:0xf
  v_mfma_f32_16x16x32_bf16 a[24:27], a[40:43], v[136:139], a[24:27]
  ds_read_b128 a[176:179], v0 offset:4096
  v_accvgpr_read_b32 v21, a253
  v_mfma_f32_16x16x32_bf16 a[24:27], a[44:47], v[148:151], a[24:27]
  ds_read_b128 a[32:35], v234 offset:32
  v_perm_b32 v79, v28, v156, v4
  v_mfma_f32_16x16x32_bf16 a[20:23], a[44:47], v[144:147], a[20:23]
  v_perm_b32 v91, v29, v157, v4
  v_perm_b32 v87, v30, v158, v4
  v_mfma_f32_16x16x32_bf16 a[20:23], a[40:43], v[140:143], a[20:23]
  ds_read_b32 v227, v249 offset:3360
  v_perm_b32 v83, v31, v159, v4
  v_mfma_f32_16x16x32_bf16 a[16:19], a[40:43], v[124:127], a[16:19]
  buffer_load_dwordx4 v[152:155], v2, s[36:39], s52 offen
  v_mfma_f32_16x16x32_bf16 a[16:19], a[44:47], v[108:111], a[16:19]
  s_waitcnt lgkmcnt(9)
  ds_read_b128 a[40:43], v235
  v_accvgpr_read_b32 v22, a254
  v_mfma_f32_16x16x32_bf16 v[32:35], a[48:51], v[124:127], v[32:35]
  v_mov_b32_dpp v28, v104 row_ror:8 row_mask:0xf bank_mask:0xf
  v_mov_b32_dpp v29, v105 row_ror:8 row_mask:0xf bank_mask:0xf
  v_mfma_f32_16x16x32_bf16 v[32:35], a[52:55], v[76:79], v[32:35]
  v_mov_b32_dpp v30, v100 row_ror:8 row_mask:0xf bank_mask:0xf
  v_mov_b32_dpp v31, v106 row_ror:8 row_mask:0xf bank_mask:0xf
  v_mfma_f32_16x16x32_bf16 v[36:39], a[52:55], v[88:91], v[36:39]
  ds_read_b128 a[180:183], v253 offset:4096
  v_accvgpr_read_b32 v23, a255
  v_mfma_f32_16x16x32_bf16 v[36:39], a[48:51], v[140:143], v[36:39]
  ds_read_b128 a[44:47], v235 offset:32
  v_perm_b32 v156, v28, v104, v4
  v_mfma_f32_16x16x32_bf16 v[40:43], a[48:51], v[136:139], v[40:43]
  v_perm_b32 v104, v29, v105, v4
  v_perm_b32 v157, v30, v100, v4
  v_mfma_f32_16x16x32_bf16 v[40:43], a[52:55], v[84:87], v[40:43]
  ds_read_b32 v225, v248 offset:3360
  v_perm_b32 v100, v31, v106, v4
  v_mfma_f32_16x16x32_bf16 v[44:47], a[52:55], v[80:83], v[44:47]
  buffer_load_dwordx4 v[148:151], v2, s[36:39], s52 offen offset:2048
  v_mfma_f32_16x16x32_bf16 v[44:47], a[48:51], v[132:135], v[44:47]
  s_waitcnt lgkmcnt(9)
  ds_read_b128 a[52:55], v236 offset:32
  v_add_u32_sdwa v236, v228, v5 dst_sel:DWORD dst_unused:UNUSED_PAD src0_sel:WORD_0 src1_sel:DWORD
  v_mfma_f32_16x16x32_bf16 v[60:63], a[60:63], v[132:135], v[60:63]
  v_mov_b32_dpp v28, v101 row_ror:8 row_mask:0xf bank_mask:0xf
  v_mov_b32_dpp v29, v102 row_ror:8 row_mask:0xf bank_mask:0xf
  v_mfma_f32_16x16x32_bf16 v[60:63], a[56:59], v[80:83], v[60:63]
  v_mov_b32_dpp v30, v96 row_ror:8 row_mask:0xf bank_mask:0xf
  v_mov_b32_dpp v31, v107 row_ror:8 row_mask:0xf bank_mask:0xf
  v_mfma_f32_16x16x32_bf16 v[56:59], a[56:59], v[84:87], v[56:59]
  ds_read_b128 a[184:187], v254 offset:4096
  v_accvgpr_read_b32 v26, a64
  v_mfma_f32_16x16x32_bf16 v[56:59], a[60:63], v[136:139], v[56:59]
  ds_read_b128 a[48:51], v236
  v_perm_b32 v105, v28, v101, v4
  v_mfma_f32_16x16x32_bf16 v[52:55], a[60:63], v[140:143], v[52:55]
  v_perm_b32 v101, v29, v102, v4
  v_perm_b32 v158, v30, v96, v4
  v_mfma_f32_16x16x32_bf16 v[52:55], a[56:59], v[88:91], v[52:55]
  v_perm_b32 v96, v31, v107, v4
  v_add_u32_sdwa v228, v228, v5 dst_sel:DWORD dst_unused:UNUSED_PAD src0_sel:WORD_1 src1_sel:DWORD
  v_mfma_f32_16x16x32_bf16 v[48:51], a[56:59], v[76:79], v[48:51]
  buffer_load_dwordx4 v[144:147], v3, s[36:39], s52 offen
  v_mfma_f32_16x16x32_bf16 v[48:51], a[60:63], v[124:127], v[48:51]
  s_waitcnt lgkmcnt(7)
  ds_read_b128 a[56:59], v237 offset:32
  v_add_u32_sdwa v237, v229, v5 dst_sel:DWORD dst_unused:UNUSED_PAD src0_sel:WORD_0 src1_sel:DWORD
  v_mfma_f32_16x16x32_bf16 v[160:163], a[36:39], v[124:127], v[160:163]
  v_mov_b32_dpp v28, v97 row_ror:8 row_mask:0xf bank_mask:0xf
  v_mov_b32_dpp v29, v103 row_ror:8 row_mask:0xf bank_mask:0xf
  v_mfma_f32_16x16x32_bf16 v[160:163], a[32:35], v[76:79], v[160:163]
  v_mov_b32_dpp v30, v98 row_ror:8 row_mask:0xf bank_mask:0xf
  v_mov_b32_dpp v31, v99 row_ror:8 row_mask:0xf bank_mask:0xf
  v_mfma_f32_16x16x32_bf16 v[164:167], a[32:35], v[88:91], v[164:167]
  ds_read_b128 a[188:191], v255 offset:4096
  v_add_u32_sdwa v234, v226, v5 dst_sel:DWORD dst_unused:UNUSED_PAD src0_sel:WORD_0 src1_sel:DWORD
  v_mfma_f32_16x16x32_bf16 v[164:167], a[36:39], v[140:143], v[164:167]
  ds_read_b128 a[60:63], v237
  v_perm_b32 v106, v28, v97, v4
  v_mfma_f32_16x16x32_bf16 v[168:171], a[36:39], v[136:139], v[168:171]
  v_perm_b32 v97, v29, v103, v4
  v_perm_b32 v102, v30, v98, v4
  v_mfma_f32_16x16x32_bf16 v[168:171], a[32:35], v[84:87], v[168:171]
  v_perm_b32 v98, v31, v99, v4
  v_add_u32_sdwa v235, v227, v5 dst_sel:DWORD dst_unused:UNUSED_PAD src0_sel:WORD_0 src1_sel:DWORD
  v_mfma_f32_16x16x32_bf16 v[172:175], a[32:35], v[80:83], v[172:175]
  buffer_load_dwordx4 v[108:111], v3, s[36:39], s52 offen offset:2048
  v_mfma_f32_16x16x32_bf16 v[172:175], a[36:39], v[132:135], v[172:175]
  s_waitcnt lgkmcnt(6)
  ds_read_b128 a[32:35], v238 offset:32
  v_add_u32_sdwa v238, v230, v5 dst_sel:DWORD dst_unused:UNUSED_PAD src0_sel:WORD_0 src1_sel:DWORD
  v_mfma_f32_16x16x32_bf16 v[188:191], a[40:43], v[132:135], v[188:191]
  v_mov_b32_dpp v28, v128 row_ror:8 row_mask:0xf bank_mask:0xf
  v_mov_b32_dpp v29, v129 row_ror:8 row_mask:0xf bank_mask:0xf
  v_mfma_f32_16x16x32_bf16 v[188:191], a[44:47], v[80:83], v[188:191]
  v_mov_b32_dpp v30, v130 row_ror:8 row_mask:0xf bank_mask:0xf
  v_mov_b32_dpp v31, v131 row_ror:8 row_mask:0xf bank_mask:0xf
  v_mfma_f32_16x16x32_bf16 v[184:187], a[44:47], v[84:87], v[184:187]
  v_add_u32_sdwa v232, v224, v5 dst_sel:DWORD dst_unused:UNUSED_PAD src0_sel:WORD_0 src1_sel:DWORD
  v_add_u32_sdwa v226, v226, v5 dst_sel:DWORD dst_unused:UNUSED_PAD src0_sel:WORD_1 src1_sel:DWORD
  v_mfma_f32_16x16x32_bf16 v[184:187], a[40:43], v[136:139], v[184:187]
  ds_read_b128 a[36:39], v238
  v_perm_b32 v159, v28, v128, v4
  v_mfma_f32_16x16x32_bf16 v[180:183], a[40:43], v[140:143], v[180:183]
  v_perm_b32 v107, v29, v129, v4
  v_perm_b32 v103, v30, v130, v4
  v_mfma_f32_16x16x32_bf16 v[180:183], a[44:47], v[88:91], v[180:183]
  v_perm_b32 v99, v31, v131, v4
  v_add_u32_sdwa v233, v225, v5 dst_sel:DWORD dst_unused:UNUSED_PAD src0_sel:WORD_0 src1_sel:DWORD
  v_mfma_f32_16x16x32_bf16 v[176:179], a[44:47], v[76:79], v[176:179]
  buffer_load_dwordx4 v[132:135], v14, s[36:39], s6 offen
  v_mfma_f32_16x16x32_bf16 v[176:179], a[40:43], v[124:127], v[176:179]
  s_waitcnt vmcnt(16) lgkmcnt(5)
  ds_read_b128 a[44:47], v239 offset:32
  v_add_u32_sdwa v239, v231, v5 dst_sel:DWORD dst_unused:UNUSED_PAD src0_sel:WORD_0 src1_sel:DWORD
  v_mfma_f32_16x16x32_bf16 v[192:195], a[52:55], v[76:79], v[192:195]
  v_mov_b32_dpp v28, v120 row_ror:8 row_mask:0xf bank_mask:0xf
  v_mov_b32_dpp v29, v121 row_ror:8 row_mask:0xf bank_mask:0xf
  v_mfma_f32_16x16x32_bf16 v[192:195], a[48:51], v[156:159], v[192:195]
  v_mov_b32_dpp v30, v116 row_ror:8 row_mask:0xf bank_mask:0xf
  v_mov_b32_dpp v31, v122 row_ror:8 row_mask:0xf bank_mask:0xf
  v_mfma_f32_16x16x32_bf16 v[196:199], a[48:51], v[104:107], v[196:199]
  v_add_u32_sdwa v224, v224, v5 dst_sel:DWORD dst_unused:UNUSED_PAD src0_sel:WORD_1 src1_sel:DWORD
  v_add_u32_sdwa v225, v225, v5 dst_sel:DWORD dst_unused:UNUSED_PAD src0_sel:WORD_1 src1_sel:DWORD
  v_mfma_f32_16x16x32_bf16 v[196:199], a[52:55], v[88:91], v[196:199]
  ds_read_b128 a[40:43], v239
  v_perm_b32 v128, v28, v120, v4
  v_mfma_f32_16x16x32_bf16 v[200:203], a[52:55], v[84:87], v[200:203]
  v_perm_b32 v120, v29, v121, v4
  v_perm_b32 v129, v30, v116, v4
  v_mfma_f32_16x16x32_bf16 v[200:203], a[48:51], v[100:103], v[200:203]
  v_perm_b32 v116, v31, v122, v4
  v_add_u32_sdwa v227, v227, v5 dst_sel:DWORD dst_unused:UNUSED_PAD src0_sel:WORD_1 src1_sel:DWORD
  v_mfma_f32_16x16x32_bf16 v[204:207], a[48:51], v[96:99], v[204:207]
  buffer_load_dwordx4 v[136:139], v14, s[36:39], s6 offen offset:2048
  v_mfma_f32_16x16x32_bf16 v[204:207], a[52:55], v[80:83], v[204:207]
  s_waitcnt vmcnt(15) lgkmcnt(4)
  ds_read_b128 a[48:51], v236 offset:32
  v_add_u32_sdwa v229, v229, v5 dst_sel:DWORD dst_unused:UNUSED_PAD src0_sel:WORD_1 src1_sel:DWORD
  v_mfma_f32_16x16x32_bf16 v[220:223], a[56:59], v[80:83], v[220:223]
  v_mov_b32_dpp v28, v117 row_ror:8 row_mask:0xf bank_mask:0xf
  v_mov_b32_dpp v29, v118 row_ror:8 row_mask:0xf bank_mask:0xf
  v_mfma_f32_16x16x32_bf16 v[220:223], a[60:63], v[96:99], v[220:223]
  v_mov_b32_dpp v30, v112 row_ror:8 row_mask:0xf bank_mask:0xf
  v_mov_b32_dpp v31, v123 row_ror:8 row_mask:0xf bank_mask:0xf
  v_mfma_f32_16x16x32_bf16 v[216:219], a[60:63], v[100:103], v[216:219]
  v_add_u32_sdwa v230, v230, v5 dst_sel:DWORD dst_unused:UNUSED_PAD src0_sel:WORD_1 src1_sel:DWORD
  v_add_u32_sdwa v231, v231, v5 dst_sel:DWORD dst_unused:UNUSED_PAD src0_sel:WORD_1 src1_sel:DWORD
  v_mfma_f32_16x16x32_bf16 v[216:219], a[56:59], v[84:87], v[216:219]
  ds_read_b128 a[52:55], v237 offset:32
  v_perm_b32 v121, v28, v117, v4
  v_mfma_f32_16x16x32_bf16 v[212:215], a[56:59], v[88:91], v[212:215]
  v_perm_b32 v117, v29, v118, v4
  v_perm_b32 v130, v30, v112, v4
  v_mfma_f32_16x16x32_bf16 v[212:215], a[60:63], v[104:107], v[212:215]
  ds_read_b128 a[96:99], v234 offset:32
  v_perm_b32 v112, v31, v123, v4
  v_mfma_f32_16x16x32_bf16 v[208:211], a[60:63], v[156:159], v[208:211]
  buffer_load_dwordx4 v[140:143], v14, s[36:39], s7 offen
  v_mfma_f32_16x16x32_bf16 v[208:211], a[56:59], v[76:79], v[208:211]
  s_waitcnt lgkmcnt(5)
  ds_read_b128 a[60:63], v235
  v_mfma_f32_16x16x32_bf16 a[0:3], a[32:35], v[76:79], a[0:3]
  v_mov_b32_dpp v28, v113 row_ror:8 row_mask:0xf bank_mask:0xf
  v_mov_b32_dpp v29, v119 row_ror:8 row_mask:0xf bank_mask:0xf
  v_mfma_f32_16x16x32_bf16 a[0:3], a[36:39], v[156:159], a[0:3]
  v_mov_b32_dpp v30, v114 row_ror:8 row_mask:0xf bank_mask:0xf
  v_mov_b32_dpp v31, v115 row_ror:8 row_mask:0xf bank_mask:0xf
  v_mfma_f32_16x16x32_bf16 a[4:7], a[36:39], v[104:107], a[4:7]
  ds_read_b128 a[100:103], v226
  v_mfma_f32_16x16x32_bf16 a[4:7], a[32:35], v[88:91], a[4:7]
  ds_read_b128 a[56:59], v234
  v_perm_b32 v122, v28, v113, v4
  v_mfma_f32_16x16x32_bf16 a[8:11], a[32:35], v[84:87], a[8:11]
  v_perm_b32 v113, v29, v119, v4
  v_perm_b32 v118, v30, v114, v4
  v_mfma_f32_16x16x32_bf16 a[8:11], a[36:39], v[100:103], a[8:11]
  ds_read_b128 a[104:107], v226 offset:32
  v_perm_b32 v114, v31, v115, v4
  v_mfma_f32_16x16x32_bf16 a[12:15], a[36:39], v[96:99], a[12:15]
  buffer_load_dwordx4 v[124:127], v14, s[36:39], s7 offen offset:2048
  v_mfma_f32_16x16x32_bf16 a[12:15], a[32:35], v[80:83], a[12:15]
  s_waitcnt vmcnt(15) lgkmcnt(7)
  ds_read_b128 a[36:39], v238 offset:32
  v_mfma_f32_16x16x32_bf16 a[28:31], a[44:47], v[80:83], a[28:31]
  v_mov_b32_dpp v28, v16 row_ror:8 row_mask:0xf bank_mask:0xf
  v_mov_b32_dpp v29, v17 row_ror:8 row_mask:0xf bank_mask:0xf
  v_mfma_f32_16x16x32_bf16 a[28:31], a[40:43], v[96:99], a[28:31]
  v_mov_b32_dpp v30, v18 row_ror:8 row_mask:0xf bank_mask:0xf
  v_mov_b32_dpp v31, v19 row_ror:8 row_mask:0xf bank_mask:0xf
  v_mfma_f32_16x16x32_bf16 a[24:27], a[40:43], v[100:103], a[24:27]
  ds_read_b128 a[112:115], v235 offset:32
  v_mfma_f32_16x16x32_bf16 a[24:27], a[44:47], v[84:87], a[24:27]
  ds_read_b128 a[32:35], v230
  v_perm_b32 v131, v28, v16, v4
  v_mfma_f32_16x16x32_bf16 a[20:23], a[44:47], v[88:91], a[20:23]
  v_perm_b32 v123, v29, v17, v4
  v_perm_b32 v119, v30, v18, v4
  v_mfma_f32_16x16x32_bf16 a[20:23], a[40:43], v[104:107], a[20:23]
  ds_read_b128 a[116:119], v227
  v_perm_b32 v115, v31, v19, v4
  v_mfma_f32_16x16x32_bf16 a[16:19], a[40:43], v[156:159], a[16:19]
  buffer_load_dwordx4 a[224:227], v252, s[28:31], 0 offen offset:0
  v_mfma_f32_16x16x32_bf16 a[16:19], a[44:47], v[76:79], a[16:19]
  s_waitcnt vmcnt(9) lgkmcnt(9)
  ds_read_b128 a[40:43], v239 offset:32
  v_mfma_f32_16x16x32_bf16 v[192:195], a[48:51], v[128:131], v[192:195]
  v_mov_b32_dpp v28, v72 row_ror:8 row_mask:0xf bank_mask:0xf
  v_mov_b32_dpp v29, v68 row_ror:8 row_mask:0xf bank_mask:0xf
  v_mov_b32_dpp v30, v64 row_ror:8 row_mask:0xf bank_mask:0xf
  v_mfma_f32_16x16x32_bf16 v[196:199], a[48:51], v[120:123], v[196:199]
  v_mov_b32_dpp v31, v92 row_ror:8 row_mask:0xf bank_mask:0xf
  v_perm_b32 v76, v28, v72, v4
  v_mfma_f32_16x16x32_bf16 v[200:203], a[48:51], v[116:119], v[200:203]
  ds_read_b128 a[120:123], v227 offset:32
  v_perm_b32 v77, v29, v68, v4
  v_mfma_f32_16x16x32_bf16 v[204:207], a[48:51], v[112:115], v[204:207]
  ds_read_b128 a[44:47], v231
  v_perm_b32 v78, v30, v64, v4
  v_mfma_f32_16x16x32_bf16 v[220:223], a[52:55], v[112:115], v[220:223]
  buffer_load_dwordx4 a[228:231], v252, s[28:31], 0 offen offset:16
  v_perm_b32 v79, v31, v92, v4
  v_mfma_f32_16x16x32_bf16 v[216:219], a[52:55], v[116:119], v[216:219]
  v_mov_b32_dpp v28, v73 row_ror:8 row_mask:0xf bank_mask:0xf
  v_mov_b32_dpp v29, v69 row_ror:8 row_mask:0xf bank_mask:0xf
  v_mfma_f32_16x16x32_bf16 v[212:215], a[52:55], v[120:123], v[212:215]
  buffer_load_dwordx4 a[232:235], v252, s[28:31], 0 offen offset:128
  v_mov_b32_dpp v30, v65 row_ror:8 row_mask:0xf bank_mask:0xf
  v_mfma_f32_16x16x32_bf16 v[208:211], a[52:55], v[128:131], v[208:211]
  s_waitcnt lgkmcnt(8)
  ds_read_b128 a[48:51], v228
  v_mov_b32_dpp v31, v93 row_ror:8 row_mask:0xf bank_mask:0xf
  v_mfma_f32_16x16x32_bf16 v[176:179], a[60:63], v[156:159], v[176:179]
  v_perm_b32 v88, v28, v73, v4
  v_perm_b32 v89, v29, v69, v4
  v_mfma_f32_16x16x32_bf16 v[180:183], a[60:63], v[104:107], v[180:183]
  v_perm_b32 v90, v30, v65, v4
  v_perm_b32 v91, v31, v93, v4
  v_mfma_f32_16x16x32_bf16 v[184:187], a[60:63], v[100:103], v[184:187]
  buffer_load_dwordx4 a[236:239], v252, s[28:31], 0 offen offset:144
  v_mov_b32_dpp v28, v74 row_ror:8 row_mask:0xf bank_mask:0xf
  v_mfma_f32_16x16x32_bf16 v[188:191], a[60:63], v[96:99], v[188:191]
  ds_read_b128 a[52:55], v228 offset:32
  v_mov_b32_dpp v29, v70 row_ror:8 row_mask:0xf bank_mask:0xf
  v_mfma_f32_16x16x32_bf16 v[172:175], a[56:59], v[96:99], v[172:175]
  v_mov_b32_dpp v30, v66 row_ror:8 row_mask:0xf bank_mask:0xf
  v_mov_b32_dpp v31, v94 row_ror:8 row_mask:0xf bank_mask:0xf
  v_mfma_f32_16x16x32_bf16 v[172:175], a[96:99], v[112:115], v[172:175]
  v_perm_b32 v84, v28, v74, v4
  v_perm_b32 v85, v29, v70, v4
  v_mfma_f32_16x16x32_bf16 v[168:171], a[96:99], v[116:119], v[168:171]
  v_perm_b32 v86, v30, v66, v4
  v_perm_b32 v87, v31, v94, v4
  v_mfma_f32_16x16x32_bf16 v[168:171], a[56:59], v[100:103], v[168:171]
  s_waitcnt vmcnt(8) lgkmcnt(6)
  ds_read_b128 a[60:63], v229
  v_mov_b32_dpp v28, v75 row_ror:8 row_mask:0xf bank_mask:0xf
  v_mfma_f32_16x16x32_bf16 v[164:167], a[56:59], v[104:107], v[164:167]
  v_mov_b32_dpp v29, v71 row_ror:8 row_mask:0xf bank_mask:0xf
  v_mov_b32_dpp v30, v67 row_ror:8 row_mask:0xf bank_mask:0xf
  v_mfma_f32_16x16x32_bf16 v[164:167], a[96:99], v[120:123], v[164:167]
  v_mov_b32_dpp v31, v95 row_ror:8 row_mask:0xf bank_mask:0xf
  v_perm_b32 v80, v28, v75, v4
  v_mfma_f32_16x16x32_bf16 v[160:163], a[96:99], v[128:131], v[160:163]
  buffer_load_dwordx4 a[192:195], v25, s[28:31], 0 offen offset:0
  v_perm_b32 v81, v29, v71, v4
  v_mfma_f32_16x16x32_bf16 v[160:163], a[56:59], v[156:159], v[160:163]
  ds_read_b128 a[56:59], v229 offset:32
  v_perm_b32 v82, v30, v67, v4
  v_mfma_f32_16x16x32_bf16 a[0:3], a[36:39], v[128:131], a[0:3]
  v_perm_b32 v83, v31, v95, v4
  v_mov_b32_dpp v28, v152 row_ror:8 row_mask:0xf bank_mask:0xf
  v_mfma_f32_16x16x32_bf16 a[0:3], a[32:35], v[76:79], a[0:3]
  v_mov_b32_dpp v29, v148 row_ror:8 row_mask:0xf bank_mask:0xf
  v_mov_b32_dpp v30, v144 row_ror:8 row_mask:0xf bank_mask:0xf
  v_mfma_f32_16x16x32_bf16 a[4:7], a[32:35], v[88:91], a[4:7]
  v_mov_b32_dpp v31, v108 row_ror:8 row_mask:0xf bank_mask:0xf
  v_perm_b32 v72, v28, v152, v4
  v_mfma_f32_16x16x32_bf16 a[4:7], a[36:39], v[120:123], a[4:7]
  s_waitcnt lgkmcnt(4)
  v_perm_b32 v73, v29, v148, v4
  v_perm_b32 v74, v30, v144, v4
  v_mfma_f32_16x16x32_bf16 a[8:11], a[36:39], v[116:119], a[8:11]
  v_perm_b32 v75, v31, v108, v4
  v_mov_b32_dpp v28, v153 row_ror:8 row_mask:0xf bank_mask:0xf
  v_mfma_f32_16x16x32_bf16 a[8:11], a[32:35], v[84:87], a[8:11]
  v_mov_b32_dpp v29, v149 row_ror:8 row_mask:0xf bank_mask:0xf
  v_mov_b32_dpp v30, v145 row_ror:8 row_mask:0xf bank_mask:0xf
  v_mfma_f32_16x16x32_bf16 a[12:15], a[32:35], v[80:83], a[12:15]
  v_mov_b32_dpp v31, v109 row_ror:8 row_mask:0xf bank_mask:0xf
  v_perm_b32 v68, v28, v153, v4
  v_mfma_f32_16x16x32_bf16 a[12:15], a[36:39], v[112:115], a[12:15]
  ds_read_b128 a[32:35], v230 offset:32
  v_perm_b32 v69, v29, v149, v4
  v_mfma_f32_16x16x32_bf16 a[28:31], a[40:43], v[112:115], a[28:31]
  v_perm_b32 v70, v30, v145, v4
  v_perm_b32 v71, v31, v109, v4
  v_mov_b32_dpp v28, v154 row_ror:8 row_mask:0xf bank_mask:0xf
  v_mfma_f32_16x16x32_bf16 a[28:31], a[44:47], v[80:83], a[28:31]
Lsh2:
Lst4:
  s_cbranch_execz Lret
  v_mov_b32_dpp v29, v150 row_ror:8 row_mask:0xf bank_mask:0xf
  v_mov_b32_dpp v30, v146 row_ror:8 row_mask:0xf bank_mask:0xf
  v_mfma_f32_16x16x32_bf16 a[24:27], a[44:47], v[84:87], a[24:27]
  v_mov_b32_dpp v31, v110 row_ror:8 row_mask:0xf bank_mask:0xf
  v_perm_b32 v64, v28, v154, v4
  v_mfma_f32_16x16x32_bf16 a[24:27], a[40:43], v[116:119], a[24:27]
  s_waitcnt vmcnt(5) lgkmcnt(3)
  ds_read_b128 a[36:39], v246
  v_perm_b32 v65, v29, v150, v4
  v_mfma_f32_16x16x32_bf16 a[20:23], a[40:43], v[120:123], a[20:23]
  buffer_load_dwordx4 a[196:199], v25, s[28:31], 0 offen offset:64
  v_perm_b32 v66, v30, v146, v4
  v_mfma_f32_16x16x32_bf16 a[20:23], a[44:47], v[88:91], a[20:23]
  v_perm_b32 v67, v31, v110, v4
  v_mov_b32_dpp v28, v155 row_ror:8 row_mask:0xf bank_mask:0xf
  v_mfma_f32_16x16x32_bf16 a[16:19], a[44:47], v[76:79], a[16:19]
  v_mov_b32_dpp v29, v151 row_ror:8 row_mask:0xf bank_mask:0xf
  v_mov_b32_dpp v30, v147 row_ror:8 row_mask:0xf bank_mask:0xf
  v_mfma_f32_16x16x32_bf16 a[16:19], a[40:43], v[128:131], a[16:19]
  ds_read_b128 a[44:47], v231 offset:32
  v_mov_b32_dpp v31, v111 row_ror:8 row_mask:0xf bank_mask:0xf
  v_mfma_f32_16x16x32_bf16 v[192:195], a[48:51], v[76:79], v[192:195]
  v_perm_b32 v92, v28, v155, v4
  v_perm_b32 v93, v29, v151, v4
  v_mfma_f32_16x16x32_bf16 v[192:195], a[52:55], v[72:75], v[192:195]
  v_perm_b32 v94, v30, v147, v4
  v_perm_b32 v95, v31, v111, v4
  v_mfma_f32_16x16x32_bf16 v[196:199], a[52:55], v[68:71], v[196:199]
  v_mov_b32_dpp v28, v132 row_ror:8 row_mask:0xf bank_mask:0xf
  v_mov_b32_dpp v29, v136 row_ror:8 row_mask:0xf bank_mask:0xf
  v_mfma_f32_16x16x32_bf16 v[196:199], a[48:51], v[88:91], v[196:199]
  s_waitcnt lgkmcnt(3)
  ds_read_b128 a[40:43], v247
  v_mov_b32_dpp v30, v140 row_ror:8 row_mask:0xf bank_mask:0xf
  v_mfma_f32_16x16x32_bf16 v[200:203], a[48:51], v[84:87], v[200:203]
  v_mov_b32_dpp v31, v124 row_ror:8 row_mask:0xf bank_mask:0xf
  v_perm_b32 v152, v28, v132, v4
  v_mfma_f32_16x16x32_bf16 v[200:203], a[52:55], v[64:67], v[200:203]
  v_perm_b32 v153, v29, v136, v4
  v_perm_b32 v154, v30, v140, v4
  v_mfma_f32_16x16x32_bf16 v[204:207], a[52:55], v[92:95], v[204:207]
  v_perm_b32 v155, v31, v124, v4
  v_mov_b32_dpp v28, v133 row_ror:8 row_mask:0xf bank_mask:0xf
  v_mfma_f32_16x16x32_bf16 v[204:207], a[48:51], v[80:83], v[204:207]
  ds_read_b128 a[52:55], v244
  v_mov_b32_dpp v29, v137 row_ror:8 row_mask:0xf bank_mask:0xf
  v_mfma_f32_16x16x32_bf16 v[220:223], a[60:63], v[80:83], v[220:223]
  v_mov_b32_dpp v30, v141 row_ror:8 row_mask:0xf bank_mask:0xf
  v_mov_b32_dpp v31, v125 row_ror:8 row_mask:0xf bank_mask:0xf
  v_mfma_f32_16x16x32_bf16 v[220:223], a[56:59], v[92:95], v[220:223]
  v_perm_b32 v148, v28, v133, v4
  v_perm_b32 v149, v29, v137, v4
  v_mfma_f32_16x16x32_bf16 v[216:219], a[56:59], v[64:67], v[216:219]
  buffer_load_dwordx4 a[200:203], v25, s[28:31], 0 offen offset:128
  v_perm_b32 v150, v30, v141, v4
  v_mfma_f32_16x16x32_bf16 v[216:219], a[60:63], v[84:87], v[216:219]
  s_waitcnt lgkmcnt(3)
  ds_read_b128 a[48:51], v245
  v_perm_b32 v151, v31, v125, v4
  v_mfma_f32_16x16x32_bf16 v[212:215], a[60:63], v[88:91], v[212:215]
  v_mov_b32_dpp v28, v134 row_ror:8 row_mask:0xf bank_mask:0xf
  v_mov_b32_dpp v29, v138 row_ror:8 row_mask:0xf bank_mask:0xf
  v_mfma_f32_16x16x32_bf16 v[212:215], a[56:59], v[68:71], v[212:215]
  v_mov_b32_dpp v30, v142 row_ror:8 row_mask:0xf bank_mask:0xf
  v_mov_b32_dpp v31, v126 row_ror:8 row_mask:0xf bank_mask:0xf
  v_mfma_f32_16x16x32_bf16 v[208:211], a[56:59], v[72:75], v[208:211]
  v_perm_b32 v144, v28, v134, v4
  v_perm_b32 v145, v29, v138, v4
  v_mfma_f32_16x16x32_bf16 v[208:211], a[60:63], v[76:79], v[208:211]
  ds_read_b128 a[56:59], v232
  v_perm_b32 v146, v30, v142, v4
  v_mfma_f32_16x16x32_bf16 a[0:3], a[32:35], v[72:75], a[0:3]
  v_perm_b32 v147, v31, v126, v4
  v_mov_b32_dpp v28, v135 row_ror:8 row_mask:0xf bank_mask:0xf
  v_mfma_f32_16x16x32_bf16 a[0:3], a[36:39], v[152:155], a[0:3]
  v_mov_b32_dpp v29, v139 row_ror:8 row_mask:0xf bank_mask:0xf
  v_mov_b32_dpp v30, v143 row_ror:8 row_mask:0xf bank_mask:0xf
  v_mfma_f32_16x16x32_bf16 a[4:7], a[36:39], v[148:151], a[4:7]
  v_mov_b32_dpp v31, v127 row_ror:8 row_mask:0xf bank_mask:0xf
  v_perm_b32 v108, v28, v135, v4
  v_mfma_f32_16x16x32_bf16 a[4:7], a[32:35], v[68:71], a[4:7]
  s_waitcnt lgkmcnt(3)
  ds_read_b128 a[60:63], v233
  v_perm_b32 v109, v29, v139, v4
  v_mfma_f32_16x16x32_bf16 a[8:11], a[32:35], v[64:67], a[8:11]
  v_perm_b32 v110, v30, v143, v4
  v_perm_b32 v111, v31, v127, v4
  v_mfma_f32_16x16x32_bf16 a[8:11], a[36:39], v[144:147], a[8:11]
  ds_read_b128 a[64:67], v232 offset:32
  v_accvgpr_read_b32 v19, a80
  v_mfma_f32_16x16x32_bf16 a[12:15], a[36:39], v[108:111], a[12:15]
  ds_read_b128 a[68:71], v224
  v_accvgpr_read_b32 v132, a0
  v_mfma_f32_16x16x32_bf16 a[12:15], a[32:35], v[92:95], a[12:15]
  ds_read_b128 a[72:75], v224 offset:32
  v_accvgpr_read_b32 v133, a1
  v_mfma_f32_16x16x32_bf16 a[28:31], a[44:47], v[92:95], a[28:31]
  buffer_load_dwordx4 a[204:207], v25, s[28:31], 0 offen offset:192
  v_accvgpr_read_b32 v134, a2
  v_mfma_f32_16x16x32_bf16 a[28:31], a[40:43], v[108:111], a[28:31]
  v_accvgpr_read_b32 v135, a3
  v_cvt_pk_bf16_f32 v132, v132, v133
  v_mfma_f32_16x16x32_bf16 a[24:27], a[40:43], v[144:147], a[24:27]
  v_cvt_pk_bf16_f32 v133, v134, v135
  v_accvgpr_read_b32 v136, a4
  v_mfma_f32_16x16x32_bf16 a[24:27], a[44:47], v[64:67], a[24:27]
  s_waitcnt lgkmcnt(6)
  v_accvgpr_read_b32 v137, a5
  v_accvgpr_read_b32 v138, a6
  v_mfma_f32_16x16x32_bf16 a[20:23], a[44:47], v[68:71], a[20:23]
  v_accvgpr_read_b32 v139, a7
  v_cvt_pk_bf16_f32 v134, v136, v137
  v_mfma_f32_16x16x32_bf16 a[20:23], a[40:43], v[148:151], a[20:23]
  v_cvt_pk_bf16_f32 v135, v138, v139
  v_accvgpr_read_b32 v140, a8
  v_mfma_f32_16x16x32_bf16 a[16:19], a[40:43], v[152:155], a[16:19]
  ds_write2st64_b64 v26, v[132:133], v[134:135] offset0:16 offset1:17
  v_mfma_f32_16x16x32_bf16 a[16:19], a[44:47], v[72:75], a[16:19]
  v_accvgpr_read_b32 v141, a9
  v_accvgpr_read_b32 v142, a10
  v_mfma_f32_16x16x32_bf16 v[192:195], a[52:55], v[152:155], v[192:195]
  buffer_load_dword v9, v13, s[40:43], 0 offen sc1
  v_accvgpr_read_b32 v143, a11
  v_mfma_f32_16x16x32_bf16 v[196:199], a[52:55], v[148:151], v[196:199]
  v_cvt_pk_bf16_f32 v140, v140, v141
  v_cvt_pk_bf16_f32 v141, v142, v143
  v_mfma_f32_16x16x32_bf16 v[200:203], a[52:55], v[144:147], v[200:203]
  buffer_load_dwordx4 a[208:211], v1, s[28:31], 0 offen offset:0
  v_accvgpr_read_b32 v124, a12
  v_mfma_f32_16x16x32_bf16 v[204:207], a[52:55], v[108:111], v[204:207]
  s_waitcnt lgkmcnt(6)
  v_accvgpr_read_b32 v125, a13
  v_accvgpr_read_b32 v126, a14
  v_mfma_f32_16x16x32_bf16 v[220:223], a[48:51], v[108:111], v[220:223]
  v_accvgpr_read_b32 v127, a15
  v_cvt_pk_bf16_f32 v142, v124, v125
  v_mfma_f32_16x16x32_bf16 v[216:219], a[48:51], v[144:147], v[216:219]
  v_cvt_pk_bf16_f32 v143, v126, v127
  v_accvgpr_read_b32 v132, a24
  v_mfma_f32_16x16x32_bf16 v[212:215], a[48:51], v[148:151], v[212:215]
  ds_write2st64_b64 v26, v[140:141], v[142:143] offset0:18 offset1:19
  v_mfma_f32_16x16x32_bf16 v[208:211], a[48:51], v[152:155], v[208:211]
  v_accvgpr_read_b32 v133, a25
  v_accvgpr_read_b32 v134, a26
  v_mfma_f32_16x16x32_bf16 v[160:163], a[100:103], v[76:79], v[160:163]
  v_accvgpr_read_b32 v135, a27
  v_cvt_pk_bf16_f32 v132, v132, v133
  v_mfma_f32_16x16x32_bf16 v[160:163], a[104:107], v[72:75], v[160:163]
  v_cvt_pk_bf16_f32 v133, v134, v135
  v_accvgpr_read_b32 v136, a28
  v_mfma_f32_16x16x32_bf16 v[160:163], a[108:111], v[152:155], v[160:163]
  v_accvgpr_read_b32 v137, a29
  v_accvgpr_read_b32 v138, a30
  v_mfma_f32_16x16x32_bf16 v[164:167], a[100:103], v[88:91], v[164:167]
  v_accvgpr_read_b32 v139, a31
  v_cvt_pk_bf16_f32 v134, v136, v137
  v_mfma_f32_16x16x32_bf16 v[164:167], a[104:107], v[68:71], v[164:167]
  v_cvt_pk_bf16_f32 v135, v138, v139
  v_accvgpr_read_b32 v140, a16
  v_mfma_f32_16x16x32_bf16 v[164:167], a[108:111], v[148:151], v[164:167]
  ds_write2st64_b64 v26, v[132:133], v[134:135] offset0:22 offset1:23
  v_mfma_f32_16x16x32_bf16 v[168:171], a[100:103], v[84:87], v[168:171]
  v_accvgpr_read_b32 v141, a17
  v_accvgpr_read_b32 v142, a18
  v_mfma_f32_16x16x32_bf16 v[168:171], a[104:107], v[64:67], v[168:171]
  v_accvgpr_read_b32 v143, a19
  v_cvt_pk_bf16_f32 v140, v140, v141
  v_mfma_f32_16x16x32_bf16 v[168:171], a[108:111], v[144:147], v[168:171]
  buffer_load_dwordx4 a[212:215], v1, s[28:31], 0 offen offset:64
  v_cvt_pk_bf16_f32 v141, v142, v143
  v_mfma_f32_16x16x32_bf16 v[172:175], a[100:103], v[80:83], v[172:175]
  v_accvgpr_read_b32 v124, a20
  v_accvgpr_read_b32 v125, a21
  v_mfma_f32_16x16x32_bf16 v[172:175], a[104:107], v[92:95], v[172:175]
  v_accvgpr_read_b32 v126, a22
  v_accvgpr_read_b32 v127, a23
  v_mfma_f32_16x16x32_bf16 v[172:175], a[108:111], v[108:111], v[172:175]
  v_cvt_pk_bf16_f32 v142, v124, v125
  v_cvt_pk_bf16_f32 v143, v126, v127
  v_mfma_f32_16x16x32_bf16 v[176:179], a[112:115], v[128:131], v[176:179]
  ds_write2st64_b64 v26, v[140:141], v[142:143] offset0:20 offset1:21
  v_mfma_f32_16x16x32_bf16 v[176:179], a[116:119], v[76:79], v[176:179]
  v_cvt_pk_bf16_f32 v192, v192, v193
  v_cvt_pk_bf16_f32 v193, v194, v195
  v_mfma_f32_16x16x32_bf16 v[176:179], a[120:123], v[72:75], v[176:179]
  v_cvt_pk_bf16_f32 v194, v196, v197
  v_cvt_pk_bf16_f32 v195, v198, v199
  v_mfma_f32_16x16x32_bf16 v[176:179], a[124:127], v[152:155], v[176:179]
  ds_write_b128 v19, v[192:195] offset:4096
  v_mfma_f32_16x16x32_bf16 v[180:183], a[112:115], v[120:123], v[180:183]
  v_cvt_pk_bf16_f32 v200, v200, v201
  v_cvt_pk_bf16_f32 v201, v202, v203
  v_mfma_f32_16x16x32_bf16 v[180:183], a[116:119], v[88:91], v[180:183]
  v_cvt_pk_bf16_f32 v202, v204, v205
  v_cvt_pk_bf16_f32 v203, v206, v207
  v_mfma_f32_16x16x32_bf16 v[180:183], a[120:123], v[68:71], v[180:183]
  ds_write_b128 v19, v[200:203] offset:5120
  v_mfma_f32_16x16x32_bf16 v[180:183], a[124:127], v[148:151], v[180:183]
  v_cvt_pk_bf16_f32 v216, v216, v217
  v_cvt_pk_bf16_f32 v217, v218, v219
  v_mfma_f32_16x16x32_bf16 v[184:187], a[112:115], v[116:119], v[184:187]
  v_cvt_pk_bf16_f32 v218, v220, v221
  v_cvt_pk_bf16_f32 v219, v222, v223
  v_mfma_f32_16x16x32_bf16 v[184:187], a[116:119], v[84:87], v[184:187]
  ds_write_b128 v19, v[216:219] offset:7168
  v_mfma_f32_16x16x32_bf16 v[184:187], a[120:123], v[64:67], v[184:187]
  buffer_load_dwordx4 a[216:219], v1, s[28:31], 0 offen offset:128
  v_cvt_pk_bf16_f32 v208, v208, v209
  v_mfma_f32_16x16x32_bf16 v[184:187], a[124:127], v[144:147], v[184:187]
  v_cvt_pk_bf16_f32 v209, v210, v211
  v_cvt_pk_bf16_f32 v210, v212, v213
  v_mfma_f32_16x16x32_bf16 v[188:191], a[112:115], v[112:115], v[188:191]
  v_cvt_pk_bf16_f32 v211, v214, v215
  v_cvt_pk_bf16_f32 v160, v160, v161
  v_mfma_f32_16x16x32_bf16 v[188:191], a[116:119], v[80:83], v[188:191]
  ds_write_b128 v19, v[208:211] offset:6144
  v_mfma_f32_16x16x32_bf16 v[188:191], a[120:123], v[92:95], v[188:191]
  v_cvt_pk_bf16_f32 v161, v162, v163
  v_cvt_pk_bf16_f32 v162, v164, v165
  v_mfma_f32_16x16x32_bf16 v[188:191], a[124:127], v[108:111], v[188:191]
  s_waitcnt lgkmcnt(12)
  v_cvt_pk_bf16_f32 v163, v166, v167
  v_cvt_pk_bf16_f32 v168, v168, v169
  v_mfma_f32_16x16x32_bf16 v[32:35], a[56:59], v[156:159], v[32:35]
  s_waitcnt lgkmcnt(8)
  ds_write_b128 v19, v[160:163] offset:0
  v_mfma_f32_16x16x32_bf16 v[32:35], a[64:67], v[128:131], v[32:35]
  v_cvt_pk_bf16_f32 v169, v170, v171
  v_cvt_pk_bf16_f32 v170, v172, v173
  v_mfma_f32_16x16x32_bf16 v[32:35], a[68:71], v[76:79], v[32:35]
  v_cvt_pk_bf16_f32 v171, v174, v175
  v_cvt_pk_bf16_f32 v176, v176, v177
  v_mfma_f32_16x16x32_bf16 v[32:35], a[72:75], v[72:75], v[32:35]
  ds_write_b128 v19, v[168:171] offset:1024
  v_mfma_f32_16x16x32_bf16 v[32:35], a[76:79], v[152:155], v[32:35]
  v_cvt_pk_bf16_f32 v177, v178, v179
  v_cvt_pk_bf16_f32 v178, v180, v181
  v_mfma_f32_16x16x32_bf16 v[36:39], a[56:59], v[104:107], v[36:39]
  v_cvt_pk_bf16_f32 v179, v182, v183
  v_cvt_pk_bf16_f32 v184, v184, v185
  v_mfma_f32_16x16x32_bf16 v[36:39], a[64:67], v[120:123], v[36:39]
  ds_write_b128 v19, v[176:179] offset:2048
  v_mfma_f32_16x16x32_bf16 v[36:39], a[68:71], v[88:91], v[36:39]
  v_cvt_pk_bf16_f32 v185, v186, v187
  v_cvt_pk_bf16_f32 v186, v188, v189
  v_mfma_f32_16x16x32_bf16 v[36:39], a[72:75], v[68:71], v[36:39]
  buffer_load_dwordx4 a[220:223], v1, s[28:31], 0 offen offset:192
  v_cvt_pk_bf16_f32 v187, v190, v191
  v_mfma_f32_16x16x32_bf16 v[36:39], a[76:79], v[148:151], v[36:39]
  ds_write_b128 v19, v[184:187] offset:3072
  v_mfma_f32_16x16x32_bf16 v[40:43], a[56:59], v[100:103], v[40:43]
  v_accvgpr_read_b32 v16, a81
  v_accvgpr_read_b32 v17, a82
  v_mfma_f32_16x16x32_bf16 v[40:43], a[64:67], v[116:119], v[40:43]
  global_load_dwordx4 v[176:179], v22, s[12:13]
  v_accvgpr_read_b32 v18, a83
  v_mfma_f32_16x16x32_bf16 v[40:43], a[68:71], v[84:87], v[40:43]
  s_waitcnt vmcnt(5) lgkmcnt(0)
  s_barrier
  ds_read_b128 a[80:83], v233 offset:32
  v_mfma_f32_16x16x32_bf16 v[40:43], a[72:75], v[64:67], v[40:43]
  ds_read_b128 a[84:87], v225
  v_cmp_ne_u32 vcc, v12, v9
  v_mfma_f32_16x16x32_bf16 v[40:43], a[76:79], v[144:147], v[40:43]
  ds_read_b128 a[88:91], v225 offset:32
  global_load_dwordx4 v[184:187], v22, s[14:15]
  v_mfma_f32_16x16x32_bf16 v[44:47], a[56:59], v[96:99], v[44:47]
  ds_read_b64 a[0:1], v18 offset:8192
  v_mfma_f32_16x16x32_bf16 v[44:47], a[64:67], v[112:115], v[44:47]
  s_cbranch_vccnz Lchk
Lchkok:
  ds_read_b128 a[2:5], v16 offset:0
  v_mfma_f32_16x16x32_bf16 v[44:47], a[68:71], v[80:83], v[44:47]
  s_mov_b32 vcc_lo, 0x00ff00ff
  ds_read_b128 a[6:9], v17 offset:4096
  v_mfma_f32_16x16x32_bf16 v[44:47], a[72:75], v[92:95], v[44:47]
  s_mov_b32 vcc_hi, 0x00ff00ff
  ds_read_b64 a[10:11], v18 offset:8704
  v_mfma_f32_16x16x32_bf16 v[44:47], a[76:79], v[108:111], v[44:47]
  ds_read_b64 a[12:13], v18 offset:9216
  v_mfma_f32_16x16x32_bf16 v[48:51], a[60:63], v[156:159], v[48:51]
  ds_read_b128 a[14:17], v16 offset:1024
  v_mfma_f32_16x16x32_bf16 v[48:51], a[92:95], v[152:155], v[48:51]
  ds_read_b128 a[18:21], v17 offset:5120
  v_mfma_f32_16x16x32_bf16 v[52:55], a[60:63], v[104:107], v[52:55]
  ds_read_b64 a[22:23], v18 offset:9728
  v_mfma_f32_16x16x32_bf16 v[52:55], a[92:95], v[148:151], v[52:55]
  s_waitcnt lgkmcnt(4)
  ds_read_b64 a[96:97], v18 offset:10240
  v_smfmac_f32_16x16x64_bf16 v[32:35], a[240:243], a[0:7], v23
  ds_read_b128 a[98:101], v16 offset:2048
  v_mfma_f32_16x16x32_bf16 v[56:59], a[60:63], v[100:103], v[56:59]
  ds_read_b128 a[102:105], v17 offset:6144
  v_smfmac_f32_16x16x64_bf16 v[36:39], a[244:247], a[4:11], v23
  ds_read_b64 a[106:107], v18 offset:10752
  v_mfma_f32_16x16x32_bf16 v[56:59], a[92:95], v[144:147], v[56:59]
  s_waitcnt lgkmcnt(4)
  ds_read_b64 a[108:109], v18 offset:11264
  v_smfmac_f32_16x16x64_bf16 v[40:43], a[240:243], a[12:19], v23
  ds_read_b128 a[110:113], v16 offset:3072
  v_mfma_f32_16x16x32_bf16 v[60:63], a[60:63], v[96:99], v[60:63]
  ds_read_b128 a[114:117], v17 offset:7168
  v_cvt_pk_bf16_f32 v192, v32, v36
  v_smfmac_f32_16x16x64_bf16 v[44:47], a[244:247], a[16:23], v23
  ds_read_b64 a[118:119], v18 offset:11776
  v_mfma_f32_16x16x32_bf16 v[48:51], a[80:83], v[128:131], v[48:51]
  v_cvt_pk_bf16_f32 v194, v33, v37
  v_cvt_pk_bf16_f32 v196, v34, v38
  v_mfma_f32_16x16x32_bf16 v[48:51], a[84:87], v[76:79], v[48:51]
  v_cvt_pk_bf16_f32 v198, v35, v39
  v_cndmask_b32_dpp v200, v194, v192, vcc row_ror:8 row_mask:0xf bank_mask:0xf
  v_mfma_f32_16x16x32_bf16 v[48:51], a[88:91], v[72:75], v[48:51]
  s_waitcnt lgkmcnt(4)
  v_cvt_pk_bf16_f32 v193, v40, v44
  v_cvt_pk_bf16_f32 v195, v41, v45
  v_smfmac_f32_16x16x64_bf16 v[48:51], a[240:243], a[96:103], v23
  v_cvt_pk_bf16_f32 v197, v42, v46
  v_mfma_f32_16x16x32_bf16 v[52:55], a[80:83], v[120:123], v[52:55]
  v_cvt_pk_bf16_f32 v199, v43, v47
  v_cndmask_b32_dpp v204, v198, v196, vcc row_ror:8 row_mask:0xf bank_mask:0xf
  v_mfma_f32_16x16x32_bf16 v[52:55], a[84:87], v[88:91], v[52:55]
  v_cndmask_b32_dpp v201, v195, v193, vcc row_ror:8 row_mask:0xf bank_mask:0xf
  v_cndmask_b32_dpp v205, v199, v197, vcc row_ror:8 row_mask:0xf bank_mask:0xf
  v_mfma_f32_16x16x32_bf16 v[52:55], a[88:91], v[68:71], v[52:55]
  s_not_b64 vcc, vcc
  v_cndmask_b32_dpp v202, v192, v194, vcc row_ror:8 row_mask:0xf bank_mask:0xf
  v_cndmask_b32_dpp v206, v196, v198, vcc row_ror:8 row_mask:0xf bank_mask:0xf
  v_smfmac_f32_16x16x64_bf16 v[52:55], a[244:247], a[100:107], v23
  s_nop 0
  v_cndmask_b32_dpp v203, v193, v195, vcc row_ror:8 row_mask:0xf bank_mask:0xf
  v_mfma_f32_16x16x32_bf16 v[56:59], a[80:83], v[116:119], v[56:59]
  buffer_store_dwordx4 v[200:203], v15, s[40:43], s68 offen sc1
  v_cndmask_b32_dpp v207, v197, v199, vcc row_ror:8 row_mask:0xf bank_mask:0xf
  v_mfma_f32_16x16x32_bf16 v[56:59], a[84:87], v[84:87], v[56:59]
  v_mfma_f32_16x16x32_bf16 v[56:59], a[88:91], v[64:67], v[56:59]
  s_waitcnt lgkmcnt(0)
  v_cvt_pk_bf16_f32 v160, v48, v52
  v_cvt_pk_bf16_f32 v162, v49, v53
  v_smfmac_f32_16x16x64_bf16 v[56:59], a[240:243], a[108:115], v23
  buffer_store_dwordx4 v[204:207], v15, s[40:43], s68 offen offset:2048 sc1
  v_mfma_f32_16x16x32_bf16 v[60:63], a[92:95], v[108:111], v[60:63]
  v_cvt_pk_bf16_f32 v164, v50, v54
  v_cvt_pk_bf16_f32 v166, v51, v55
  v_mfma_f32_16x16x32_bf16 v[60:63], a[80:83], v[112:115], v[60:63]
  v_cndmask_b32_dpp v170, v160, v162, vcc row_ror:8 row_mask:0xf bank_mask:0xf
  v_cndmask_b32_dpp v174, v164, v166, vcc row_ror:8 row_mask:0xf bank_mask:0xf
  v_mfma_f32_16x16x32_bf16 v[60:63], a[84:87], v[80:83], v[60:63]
  s_not_b64 vcc, vcc
  v_cndmask_b32_dpp v168, v162, v160, vcc row_ror:8 row_mask:0xf bank_mask:0xf
  v_cndmask_b32_dpp v172, v166, v164, vcc row_ror:8 row_mask:0xf bank_mask:0xf
  v_mfma_f32_16x16x32_bf16 v[60:63], a[88:91], v[92:95], v[60:63]
  v_smfmac_f32_16x16x64_bf16 v[60:63], a[244:247], a[112:119], v23
  s_nop 2
  v_mfma_f32_16x16x32_bf16 v[144:147], a[128:131], a[128:131], 0
  s_nop 2
  v_mfma_f32_16x16x32_bf16 v[144:147], a[132:135], a[132:135], v[144:147]
  v_cvt_pk_bf16_f32 v161, v56, v60
  v_cvt_pk_bf16_f32 v163, v57, v61
  v_mfma_f32_16x16x32_bf16 v[144:147], a[136:139], a[136:139], v[144:147]
  v_cvt_pk_bf16_f32 v165, v58, v62
  v_cvt_pk_bf16_f32 v167, v59, v63
  v_mfma_f32_16x16x32_bf16 v[144:147], a[140:143], a[140:143], v[144:147]
  v_cndmask_b32_dpp v169, v163, v161, vcc row_ror:8 row_mask:0xf bank_mask:0xf
  v_cndmask_b32_dpp v173, v167, v165, vcc row_ror:8 row_mask:0xf bank_mask:0xf
  v_mfma_f32_16x16x32_bf16 v[148:151], a[128:131], a[144:147], 0
  s_not_b64 vcc, vcc
  v_cndmask_b32_dpp v171, v161, v163, vcc row_ror:8 row_mask:0xf bank_mask:0xf
  v_cndmask_b32_dpp v175, v165, v167, vcc row_ror:8 row_mask:0xf bank_mask:0xf
  v_mfma_f32_16x16x32_bf16 v[148:151], a[132:135], a[148:151], v[148:151]
  buffer_store_dwordx4 v[168:171], v15, s[40:43], s61 offen sc1
  v_mfma_f32_16x16x32_bf16 v[148:151], a[136:139], a[152:155], v[148:151]
  buffer_store_dwordx4 v[172:175], v15, s[40:43], s61 offen offset:2048 sc1
  v_mfma_f32_16x16x32_bf16 v[148:151], a[140:143], a[156:159], v[148:151]
  s_mov_b32 s52, 100
  v_cvt_pk_bf16_f32 v72, v144, v145
  v_lshrrev_b32 v194, 1, v7
  v_mfma_f32_16x16x32_bf16 v[152:155], a[144:147], a[144:147], 0
  v_cvt_pk_bf16_f32 v73, v146, v147
  v_and_b32 v195, 32, v7
  v_mfma_f32_16x16x32_bf16 v[152:155], a[148:151], a[148:151], v[152:155]
  ds_read_b64 a[0:1], v20 offset:0
  v_sub_u32 v194, v20, v194
  v_mfma_f32_16x16x32_bf16 v[152:155], a[152:155], a[152:155], v[152:155]
  ds_read_b64 a[2:3], v20 offset:3232
  v_mul_i32_i24 v193, -50, v7
  v_mfma_f32_16x16x32_bf16 v[152:155], a[156:159], a[156:159], v[152:155]
  v_cvt_pk_bf16_f32 v84, v148, v149
  v_mad_u32_u24 v192, v195, s52, v194
  v_mfma_f32_16x16x32_bf16 v[156:159], a[128:131], a[160:163], 0
  v_cvt_pk_bf16_f32 v85, v150, v151
  v_add3_u32 v193, v193, v21, v195
  v_mfma_f32_16x16x32_bf16 v[156:159], a[132:135], a[164:167], v[156:159]
  ds_read_b64 a[4:5], v20 offset:6464
  v_mov_b32_dpp v194, v194 row_ror:4 row_mask:0x2 bank_mask:0xf
  v_mfma_f32_16x16x32_bf16 v[156:159], a[136:139], a[168:171], v[156:159]
  ds_read_b64 a[6:7], v20 offset:9696
  v_lshrrev_b32 v195, 16, v23
  v_mfma_f32_16x16x32_bf16 v[156:159], a[140:143], a[172:175], v[156:159]
  v_cvt_pk_bf16_f32 v74, v152, v153
  v_mov_b32 v196, 86016
  v_mfma_f32_16x16x32_bf16 v[144:147], a[144:147], a[160:163], 0
  ds_read_b128 v[48:51], v196
  v_cvt_pk_bf16_f32 v75, v154, v155
  v_mfma_f32_16x16x32_bf16 v[144:147], a[148:151], a[164:167], v[144:147]
  s_lshr_b32 s59, s64, 12
  ds_read_b128 v[52:55], v196
  v_mfma_f32_16x16x32_bf16 v[144:147], a[152:155], a[168:171], v[144:147]
  s_add_u32 s59, s59, s44
  ds_read_b128 v[56:59], v196
  v_mfma_f32_16x16x32_bf16 v[144:147], a[156:159], a[172:175], v[144:147]
  v_cvt_pk_bf16_f32 v86, v156, v157
  v_accvgpr_read_b32 v32, a224
  v_mfma_f32_16x16x32_bf16 v[148:151], a[160:163], a[160:163], 0
  s_lshl_b32 s60, s59, 1
  v_cvt_pk_bf16_f32 v87, v158, v159
  v_accvgpr_read_b32 v40, a225
  v_mfma_f32_16x16x32_bf16 v[148:151], a[164:167], a[164:167], v[148:151]
  ds_read_b64 a[8:9], v20 offset:12928
  v_accvgpr_read_b32 v33, a226
  v_mfma_f32_16x16x32_bf16 v[148:151], a[168:171], a[168:171], v[148:151]
  ds_read_b64 a[10:11], v20 offset:16160
  v_accvgpr_read_b32 v41, a227
  v_mfma_f32_16x16x32_bf16 v[148:151], a[172:175], a[172:175], v[148:151]
  v_cvt_pk_bf16_f32 v88, v144, v145
  v_accvgpr_read_b32 v34, a228
  v_mfma_f32_16x16x32_bf16 v[152:155], a[128:131], a[176:179], 0
  v_cvt_pk_bf16_f32 v89, v146, v147
  v_accvgpr_read_b32 v42, a229
  v_mfma_f32_16x16x32_bf16 v[152:155], a[132:135], a[180:183], v[152:155]
  ds_read_b64 a[12:13], v20 offset:3200
  v_accvgpr_read_b32 v35, a230
  v_mfma_f32_16x16x32_bf16 v[152:155], a[136:139], a[184:187], v[152:155]
  ds_read_b64 a[14:15], v20 offset:6400
  v_accvgpr_read_b32 v43, a231
  v_mfma_f32_16x16x32_bf16 v[152:155], a[140:143], a[188:191], v[152:155]
  v_cvt_pk_bf16_f32 v76, v148, v149
  v_accvgpr_read_b32 v36, a232
  v_mfma_f32_16x16x32_bf16 v[156:159], a[144:147], a[176:179], 0
  v_cvt_pk_bf16_f32 v77, v150, v151
  v_accvgpr_read_b32 v44, a233
  v_mfma_f32_16x16x32_bf16 v[156:159], a[148:151], a[180:183], v[156:159]
  ds_read_b64_tr_b16 a[16:17], v21 offset:32
  v_accvgpr_read_b32 v37, a234
  v_mfma_f32_16x16x32_bf16 v[156:159], a[152:155], a[184:187], v[156:159]
  ds_read_b64_tr_b16 a[18:19], v21 offset:64
  v_accvgpr_read_b32 v45, a235
  v_mfma_f32_16x16x32_bf16 v[156:159], a[156:159], a[188:191], v[156:159]
  v_cvt_pk_bf16_f32 v90, v152, v153
  v_accvgpr_read_b32 v38, a236
  v_mfma_f32_16x16x32_bf16 v[144:147], a[160:163], a[176:179], 0
  v_cvt_pk_bf16_f32 v91, v154, v155
  v_accvgpr_read_b32 v46, a237
  v_mfma_f32_16x16x32_bf16 v[144:147], a[164:167], a[180:183], v[144:147]
  ds_read_b64 a[20:21], v20 offset:6432
  v_accvgpr_read_b32 v39, a238
  v_mfma_f32_16x16x32_bf16 v[144:147], a[168:171], a[184:187], v[144:147]
  ds_read_b64 a[22:23], v20 offset:9600
  v_accvgpr_read_b32 v47, a239
  v_mfma_f32_16x16x32_bf16 v[144:147], a[172:175], a[188:191], v[144:147]
  v_cvt_pk_bf16_f32 v92, v156, v157
  v_mov_b32_dpp v32, v40 row_shr:4 row_mask:0xf bank_mask:0x2
  v_mfma_f32_16x16x32_bf16 v[148:151], a[176:179], a[176:179], 0
  v_cvt_pk_bf16_f32 v93, v158, v159
  v_mov_b32_dpp v33, v41 row_shr:4 row_mask:0xf bank_mask:0x2
  v_mfma_f32_16x16x32_bf16 v[148:151], a[180:183], a[180:183], v[148:151]
  ds_read_b64_tr_b16 a[24:25], v21 offset:3264
  v_mov_b32_dpp v34, v42 row_shr:4 row_mask:0xf bank_mask:0x2
  v_mfma_f32_16x16x32_bf16 v[148:151], a[184:187], a[184:187], v[148:151]
  ds_read_b64_tr_b16 a[26:27], v21 offset:96
  v_mov_b32_dpp v35, v43 row_shr:4 row_mask:0xf bank_mask:0x2
  v_mfma_f32_16x16x32_bf16 v[148:151], a[188:191], a[188:191], v[148:151]
  v_cvt_pk_bf16_f32 v94, v144, v145
  v_mov_b32_dpp v36, v44 row_shr:4 row_mask:0xf bank_mask:0x2
  v_mfma_f32_16x16x32_bf16 v[152:155], a[128:131], a[192:195], 0
  v_cvt_pk_bf16_f32 v95, v146, v147
  v_mov_b32_dpp v37, v45 row_shr:4 row_mask:0xf bank_mask:0x2
  v_mfma_f32_16x16x32_bf16 v[152:155], a[132:135], a[196:199], v[152:155]
  ds_read_b64 a[28:29], v20 offset:9632
  v_mov_b32_dpp v38, v46 row_shr:4 row_mask:0xf bank_mask:0x2
  v_mfma_f32_16x16x32_bf16 v[152:155], a[136:139], a[200:203], v[152:155]
  ds_read_b64 a[30:31], v20 offset:9664
  v_mov_b32_dpp v39, v47 row_shr:4 row_mask:0xf bank_mask:0x2
  v_mfma_f32_16x16x32_bf16 v[152:155], a[140:143], a[204:207], v[152:155]
  v_cvt_pk_bf16_f32 v78, v148, v149
  v_mov_b32_dpp v40, v32 row_ror:8 row_mask:0xf bank_mask:0xf
  v_mfma_f32_16x16x32_bf16 v[156:159], a[144:147], a[192:195], 0
  v_cvt_pk_bf16_f32 v79, v150, v151
  v_mov_b32_dpp v41, v33 row_ror:8 row_mask:0xf bank_mask:0xf
  v_mfma_f32_16x16x32_bf16 v[156:159], a[148:151], a[196:199], v[156:159]
  ds_read_b64_tr_b16 a[32:33], v21 offset:3296
  v_mov_b32_dpp v42, v34 row_ror:8 row_mask:0xf bank_mask:0xf
  v_mfma_f32_16x16x32_bf16 v[156:159], a[152:155], a[200:203], v[156:159]
  ds_read_b64_tr_b16 a[34:35], v21 offset:6496
  v_mov_b32_dpp v43, v35 row_ror:8 row_mask:0xf bank_mask:0xf
  v_mfma_f32_16x16x32_bf16 v[156:159], a[156:159], a[204:207], v[156:159]
  v_cvt_pk_bf16_f32 v96, v152, v153
  v_mov_b32_dpp v44, v36 row_ror:8 row_mask:0xf bank_mask:0xf
  v_mfma_f32_16x16x32_bf16 v[144:147], a[160:163], a[192:195], 0
  v_cvt_pk_bf16_f32 v97, v154, v155
  v_mov_b32_dpp v45, v37 row_ror:8 row_mask:0xf bank_mask:0xf
  v_mfma_f32_16x16x32_bf16 v[144:147], a[164:167], a[196:199], v[144:147]
  ds_read_b64 a[36:37], v20 offset:12800
  v_mov_b32_dpp v46, v38 row_ror:8 row_mask:0xf bank_mask:0xf
  v_mfma_f32_16x16x32_bf16 v[144:147], a[168:171], a[200:203], v[144:147]
  ds_read_b64 a[38:39], v20 offset:12832
  v_mov_b32_dpp v47, v39 row_ror:8 row_mask:0xf bank_mask:0xf
  v_mfma_f32_16x16x32_bf16 v[144:147], a[172:175], a[204:207], v[144:147]
  ds_read_b64_tr_b16 a[40:41], v21 offset:128
  v_cvt_pk_bf16_f32 v98, v156, v157
  v_mfma_f32_16x16x32_bf16 v[148:151], a[176:179], a[192:195], 0
  ds_read_b64_tr_b16 a[42:43], v21 offset:3328
  v_cvt_pk_bf16_f32 v99, v158, v159
  v_mfma_f32_16x16x32_bf16 v[148:151], a[180:183], a[196:199], v[148:151]
  ds_read_b64 a[44:45], v20 offset:12864
  v_mov_b32 v243, s60
  v_mfma_f32_16x16x32_bf16 v[148:151], a[184:187], a[200:203], v[148:151]
  s_mov_b32 s69, 0x10000
  ds_read_b64 a[46:47], v20 offset:12896
  v_mfma_f32_16x16x32_bf16 v[148:151], a[188:191], a[204:207], v[148:151]
  s_mov_b64 vcc, 1
  ds_read_b64_tr_b16 a[48:49], v21 offset:6528
  v_cvt_pk_bf16_f32 v100, v144, v145
  v_mfma_f32_16x16x32_bf16 v[152:155], a[192:195], a[192:195], 0
  s_mov_b32 s63, 0xbdd2d3e8
  ds_read_b64_tr_b16 a[50:51], v21 offset:9728
  v_cvt_pk_bf16_f32 v101, v146, v147
  v_mfma_f32_16x16x32_bf16 v[152:155], a[196:199], a[196:199], v[152:155]
Lsh3:
Lst5:
  s_cbranch_execz Lret
  ds_read_b64 a[52:53], v20 offset:16000
  v_mov_b32 v60, 0xc0135761
  v_mfma_f32_16x16x32_bf16 v[152:155], a[200:203], a[200:203], v[152:155]
  s_waitcnt vmcnt(4)
  ds_read_b64 a[54:55], v20 offset:16032
  v_lshlrev_b32 v10, 16, v10
  v_mfma_f32_16x16x32_bf16 v[152:155], a[204:207], a[204:207], v[152:155]
  ds_read_b64_tr_b16 a[56:57], v21 offset:160
  v_cvt_pk_bf16_f32 v102, v148, v149
  v_mfma_f32_16x16x32_bf16 v[156:159], a[128:131], a[208:211], 0
  buffer_load_dwordx4 v[128:131], v8, s[40:43], s64 offen sc1
  v_cvt_pk_bf16_f32 v103, v150, v151
  v_mfma_f32_16x16x32_bf16 v[156:159], a[132:135], a[212:215], v[156:159]
  ds_read_b64_tr_b16 a[58:59], v21 offset:3360
  v_cndmask_b32 v240, 0, v10, vcc
  v_mfma_f32_16x16x32_bf16 v[156:159], a[136:139], a[216:219], v[156:159]
  ds_read_b64 a[60:61], v20 offset:16064
  v_lshlrev_b32 v232, 16, v184
  v_mfma_f32_16x16x32_bf16 v[156:159], a[140:143], a[220:223], v[156:159]
  ds_read_b64 a[62:63], v20 offset:16096
  v_cvt_pk_bf16_f32 v80, v152, v153
  v_mfma_f32_16x16x32_bf16 v[144:147], a[144:147], a[208:211], 0
  buffer_load_dwordx4 v[132:135], v8, s[40:43], s65 offen sc1
  v_cvt_pk_bf16_f32 v81, v154, v155
  v_mfma_f32_16x16x32_bf16 v[144:147], a[148:151], a[212:215], v[144:147]
  ds_read_b64_tr_b16 a[64:65], v21 offset:6560
  v_lshlrev_b32 v64, 16, v176
  v_mfma_f32_16x16x32_bf16 v[144:147], a[152:155], a[216:219], v[144:147]
  ds_read_b64_tr_b16 a[66:67], v21 offset:9760
  v_lshlrev_b32 v233, 16, v185
  v_mfma_f32_16x16x32_bf16 v[144:147], a[156:159], a[220:223], v[144:147]
  ds_read_b64 a[68:69], v20 offset:16128
  v_cvt_pk_bf16_f32 v104, v156, v157
  v_mfma_f32_16x16x32_bf16 v[148:151], a[160:163], a[208:211], 0
  buffer_load_dwordx4 v[136:139], v8, s[40:43], s66 offen sc1
  v_cvt_pk_bf16_f32 v105, v158, v159
  v_mfma_f32_16x16x32_bf16 v[148:151], a[164:167], a[212:215], v[148:151]
  ds_read_b64_tr_b16 a[72:73], v21 offset:12960
  v_lshlrev_b32 v65, 16, v177
  v_mfma_f32_16x16x32_bf16 v[148:151], a[168:171], a[216:219], v[148:151]
  v_accvgpr_write_b32 a84, 0
  v_lshlrev_b32 v234, 16, v186
  v_mfma_f32_16x16x32_bf16 v[148:151], a[172:175], a[220:223], v[148:151]
  v_cvt_pk_bf16_f32 v106, v144, v145
  v_accvgpr_write_b32 a85, 0
  v_mfma_f32_16x16x32_bf16 v[152:155], a[176:179], a[208:211], 0
  buffer_load_dwordx4 v[140:143], v8, s[40:43], s67 offen sc1
  v_cvt_pk_bf16_f32 v107, v146, v147
  v_mfma_f32_16x16x32_bf16 v[152:155], a[180:183], a[212:215], v[152:155]
  ds_read_b64 a[70:71], v192 offset:192
  v_lshlrev_b32 v66, 16, v178
  v_mfma_f32_16x16x32_bf16 v[152:155], a[184:187], a[216:219], v[152:155]
  ds_read_b64_tr_b16 a[74:75], v193 offset:19200
  v_lshlrev_b32 v235, 16, v187
  v_mfma_f32_16x16x32_bf16 v[152:155], a[188:191], a[220:223], v[152:155]
  ds_read_b64 a[76:77], v192 offset:6592
  v_cvt_pk_bf16_f32 v108, v148, v149
  v_mfma_f32_16x16x32_bf16 v[156:159], a[192:195], a[208:211], 0
  ds_read_b64 a[78:79], v192 offset:12992
  v_cvt_pk_bf16_f32 v109, v150, v151
  v_mfma_f32_16x16x32_bf16 v[156:159], a[196:199], a[212:215], v[156:159]
  ds_read_b64_tr_b16 a[80:81], v193 offset:19264
  v_lshlrev_b32 v67, 16, v179
  v_mfma_f32_16x16x32_bf16 v[156:159], a[200:203], a[216:219], v[156:159]
  ds_read_b64_tr_b16 a[82:83], v193 offset:19328
  v_and_b32 v236, 0xffff0000, v184
  v_mfma_f32_16x16x32_bf16 v[156:159], a[204:207], a[220:223], v[156:159]
  ds_read_b64 a[86:87], v194 offset:19392
  v_cvt_pk_bf16_f32 v110, v152, v153
  v_mfma_f32_16x16x32_bf16 v[144:147], a[208:211], a[208:211], 0
  v_cvt_pk_bf16_f32 v111, v154, v155
  v_and_b32 v68, 0xffff0000, v176
  v_mfma_f32_16x16x32_bf16 v[144:147], a[212:215], a[212:215], v[144:147]
  v_and_b32 v237, 0xffff0000, v185
  v_mfma_f32_16x16x32_bf16 v[144:147], a[216:219], a[216:219], v[144:147]
  s_waitcnt lgkmcnt(15)
  v_and_b32 v69, 0xffff0000, v177
  v_mfma_f32_16x16x32_bf16 v[144:147], a[220:223], a[220:223], v[144:147]
  v_cvt_pk_bf16_f32 v112, v156, v157
  v_and_b32 v238, 0xffff0000, v186
  v_mfma_f32_16x16x32_bf16 v[148:151], v[32:35], v[32:35], 0
  v_cvt_pk_bf16_f32 v113, v158, v159
  v_and_b32 v70, 0xffff0000, v178
  v_mfma_f32_16x16x32_bf16 v[148:151], v[36:39], v[36:39], v[148:151]
  v_and_b32 v239, 0xffff0000, v187
  v_smfmac_f32_16x16x64_bf16 v[48:51], v[32:35], a[128:135], v195
  v_and_b32 v71, 0xffff0000, v179
  v_smfmac_f32_16x16x64_bf16 v[48:51], v[36:39], a[136:143], v195
  v_cvt_pk_bf16_f32 v82, v144, v145
  v_smfmac_f32_16x16x64_bf16 v[48:51], v[40:43], a[144:151], v195
  v_cvt_pk_bf16_f32 v83, v146, v147
  v_smfmac_f32_16x16x64_bf16 v[48:51], v[44:47], a[152:159], v195
  v_cvt_pk_bf16_f32 v120, v148, v149
  v_smfmac_f32_16x16x64_bf16 v[52:55], v[32:35], a[160:167], v195
  v_cvt_pk_bf16_f32 v121, v150, v151
  v_smfmac_f32_16x16x64_bf16 v[52:55], v[36:39], a[168:175], v195
  v_accvgpr_write_b32 a240, 0
  v_smfmac_f32_16x16x64_bf16 v[52:55], v[40:43], a[176:183], v195
  v_accvgpr_write_b32 a242, 0
  v_smfmac_f32_16x16x64_bf16 v[52:55], v[44:47], a[184:191], v195
  v_cvt_pk_bf16_f32 v114, v48, v49
  v_smfmac_f32_16x16x64_bf16 v[56:59], v[32:35], a[192:199], v195
  v_cvt_pk_bf16_f32 v115, v50, v51
  v_smfmac_f32_16x16x64_bf16 v[56:59], v[36:39], a[200:207], v195
  v_accvgpr_write_b32 a245, 0
  v_smfmac_f32_16x16x64_bf16 v[56:59], v[40:43], a[208:215], v195
  v_accvgpr_write_b32 a247, 0
  v_smfmac_f32_16x16x64_bf16 v[56:59], v[44:47], a[216:223], v195
  s_nop 0
  s_waitcnt lgkmcnt(0)
  v_cvt_pk_bf16_f32 v116, v52, v53
  v_mfma_f32_16x16x32_bf16 v[248:251], v[72:75], a[0:3], 0
  v_cvt_pk_bf16_f32 v117, v54, v55
  v_mfma_f32_16x16x32_bf16 v[248:251], v[76:79], a[4:7], v[248:251]
  v_mfma_f32_16x16x32_bf16 v[248:251], v[80:83], a[8:11], v[248:251]
  v_mfma_f32_16x16x32_bf16 v[248:251], v[84:87], a[12:15], v[248:251]
  v_cvt_pk_bf16_f32 v118, v56, v57
  v_mfma_f32_16x16x32_bf16 v[248:251], v[84:87], a[16:19], v[248:251]
  v_cvt_pk_bf16_f32 v119, v58, v59
  v_mfma_f32_16x16x32_bf16 v[248:251], v[88:91], a[20:23], v[248:251]
  v_mfma_f32_16x16x32_bf16 v[248:251], v[88:91], a[24:27], v[248:251]
  v_mfma_f32_16x16x32_bf16 v[248:251], v[92:95], a[28:31], v[248:251]
  v_mfma_f32_16x16x32_bf16 v[248:251], v[92:95], a[32:35], v[248:251]
  v_mfma_f32_16x16x32_bf16 v[248:251], v[96:99], a[36:39], v[248:251]
  v_mfma_f32_16x16x32_bf16 v[248:251], v[96:99], a[40:43], v[248:251]
  v_mfma_f32_16x16x32_bf16 v[248:251], v[100:103], a[44:47], v[248:251]
  v_mfma_f32_16x16x32_bf16 v[248:251], v[100:103], a[48:51], v[248:251]
  v_mfma_f32_16x16x32_bf16 v[248:251], v[104:107], a[52:55], v[248:251]
  v_mfma_f32_16x16x32_bf16 v[248:251], v[104:107], a[56:59], v[248:251]
  v_mfma_f32_16x16x32_bf16 v[248:251], v[108:111], a[60:63], v[248:251]
  v_mfma_f32_16x16x32_bf16 v[248:251], v[108:111], a[64:67], v[248:251]
  v_mfma_f32_16x16x32_bf16 v[248:251], v[112:115], a[68:71], v[248:251]
  v_mfma_f32_16x16x32_bf16 v[248:251], v[112:115], a[72:75], v[248:251]
  v_mfma_f32_16x16x32_bf16 v[248:251], v[116:119], a[76:79], v[248:251]
  v_mfma_f32_16x16x32_bf16 v[248:251], v[116:119], a[80:83], v[248:251]
  v_mfma_f32_16x16x32_bf16 v[248:251], v[118:121], a[84:87], v[248:251]
Lpoll:
  s_waitcnt vmcnt(2)
  v_smfmac_f32_16x16x64_bf16 v[64:67], a[244:247], v[128:135], v23
  v_max3_u32 v216, v128, v129, v130
  v_smfmac_f32_16x16x64_bf16 v[68:71], a[240:243], v[128:135], v23
  v_max_u32 v216, v216, v131
  v_cmp_eq_u32 s[50:51], -1, v216
  s_waitcnt vmcnt(0)
  v_smfmac_f32_16x16x64_bf16 v[64:67], a[244:247], v[136:143], v23
  v_max3_u32 v217, v132, v133, v134
  v_smfmac_f32_16x16x64_bf16 v[68:71], a[240:243], v[136:143], v23
  v_max_u32 v217, v217, v135
  v_cmp_eq_u32 s[52:53], -1, v217
  v_max3_u32 v218, v136, v137, v138
  v_max_u32 v218, v218, v139
  v_cmp_eq_u32 s[54:55], -1, v218
  v_max3_u32 v219, v140, v141, v142
  v_max_u32 v219, v219, v143
  v_cmp_eq_u32 s[56:57], -1, v219
  s_or_b64 vcc, s[50:51], s[52:53]
  s_or_b64 vcc, vcc, s[54:55]
  s_or_b64 vcc, vcc, s[56:57]
  s_cbranch_scc1 Lrep
Lpollok:
  v_pk_mul_f32 v[176:177], v[64:65], v[64:65]
  v_pk_mul_f32 v[178:179], v[66:67], v[66:67]
  v_pk_mul_f32 v[180:181], v[68:69], v[68:69]
  v_pk_mul_f32 v[182:183], v[70:71], v[70:71]
  v_pk_fma_f32 v[176:177], v[176:177], s[62:63], v[60:61] op_sel:[0,1,0] op_sel_hi:[1,1,0]
  v_pk_fma_f32 v[178:179], v[178:179], s[62:63], v[60:61] op_sel:[0,1,0] op_sel_hi:[1,1,0]
  v_pk_fma_f32 v[180:181], v[180:181], s[62:63], v[60:61] op_sel:[0,1,0] op_sel_hi:[1,1,0]
  v_pk_fma_f32 v[182:183], v[182:183], s[62:63], v[60:61] op_sel:[0,1,0] op_sel_hi:[1,1,0]
  v_pk_mul_f32 v[176:177], v[176:177], v[64:65]
  v_pk_mul_f32 v[178:179], v[178:179], v[66:67]
  v_pk_mul_f32 v[180:181], v[180:181], v[68:69]
  v_pk_mul_f32 v[182:183], v[182:183], v[70:71]
  v_cndmask_b32 v241, v248, v249, s[10:11]
  v_cndmask_b32 v248, v250, v251, s[10:11]
  v_cndmask_b32 v241, v241, v248, s[16:17]
  v_cndmask_b32 v241, 0, v241, s[20:21]
  v_exp_f32 v176, v176
  v_exp_f32 v177, v177
  v_exp_f32 v178, v178
  v_exp_f32 v179, v179
  v_exp_f32 v180, v180
  v_exp_f32 v181, v181
  v_exp_f32 v182, v182
  v_exp_f32 v183, v183
  v_pk_mul_f32 v[184:185], v[64:65], v[232:233]
  v_pk_mul_f32 v[186:187], v[66:67], v[234:235]
  v_pk_mul_f32 v[188:189], v[68:69], v[236:237]
  v_pk_mul_f32 v[190:191], v[70:71], v[238:239]
  v_pk_add_f32 v[176:177], v[176:177], 1.0 op_sel_hi:[1,0]
  v_pk_add_f32 v[178:179], v[178:179], 1.0 op_sel_hi:[1,0]
  v_pk_add_f32 v[180:181], v[180:181], 1.0 op_sel_hi:[1,0]
  v_pk_add_f32 v[182:183], v[182:183], 1.0 op_sel_hi:[1,0]
  v_rcp_f32 v176, v176
  v_rcp_f32 v177, v177
  v_rcp_f32 v178, v178
  v_rcp_f32 v179, v179
  v_rcp_f32 v180, v180
  v_rcp_f32 v181, v181
  v_rcp_f32 v182, v182
  v_rcp_f32 v183, v183
  v_pk_fma_f32 v[240:241], v[176:177], v[184:185], v[240:241]
  v_pk_mul_f32 v[178:179], v[178:179], v[186:187]
  v_pk_fma_f32 v[240:241], v[180:181], v[188:189], v[240:241]
  v_pk_fma_f32 v[178:179], v[182:183], v[190:191], v[178:179]
  v_pk_add_f32 v[240:241], v[240:241], v[178:179]
  v_add_f32 v241, v240, v241
  s_nop 1
  v_add_f32_dpp v241, v241, v241 quad_perm:[1,0,3,2] row_mask:0xf bank_mask:0xf
  s_nop 1
  v_add_f32_dpp v241, v241, v241 quad_perm:[2,3,0,1] row_mask:0xf bank_mask:0xf
  s_nop 1
  v_add_f32_dpp v241, v241, v241 row_ror:4 row_mask:0xf bank_mask:0xf
  s_nop 1
  v_add_f32_dpp v241, v241, v241 row_ror:8 row_mask:0xf bank_mask:0xf
  s_nop 1
  v_add_f32_dpp v241, v241, v241 row_bcast:15 row_mask:0xa bank_mask:0xf
  s_mov_b32 vcc_lo, 0
  s_brev_b32 vcc_hi, 1
  v_add_f32_dpp v241, v241, v241 row_bcast:31 row_mask:0xc bank_mask:0xf
  v_cvt_pk_bf16_f32 v241, v241, v241
  s_mov_b64 exec, vcc
  global_store_short v243, v241, s[18:19]
Ldone:
  s_mov_b64 exec, -1
Lend:
  s_endpgm
Lchk:
  buffer_load_dword v9, v13, s[40:43], 0 offen sc1
  s_sub_u32 s69, s69, 1
  s_cbranch_scc1 Lchkok
  s_waitcnt vmcnt(0)
  v_cmp_ne_u32 vcc, v12, v9
  s_nop 4
  s_cbranch_vccnz Lchk
  s_branch Lchkok
  s_endpgm
Ltag:
  s_mov_b32 s3, 0x10000
Ltag1:
  global_load_dword v12, v5, s[0:1] sc1
  s_sub_u32 s3, s3, 1
  s_waitcnt vmcnt(0)
  s_cbranch_scc1 Ltagok
  v_cmp_eq_u32 vcc, 0, v12
  s_nop 4
  s_cbranch_vccnz Ltag1
  s_branch Ltagok
  s_endpgm
Lrep:
  s_sub_u32 s69, s69, 1
  s_cbranch_scc1 Lpollok
  s_mov_b64 exec, s[50:51]
  buffer_load_dwordx4 v[128:131], v8, s[40:43], s64 offen sc1
  s_mov_b64 exec, s[52:53]
  buffer_load_dwordx4 v[132:135], v8, s[40:43], s65 offen sc1
  s_mov_b64 exec, s[54:55]
  buffer_load_dwordx4 v[136:139], v8, s[40:43], s66 offen sc1
  s_mov_b64 exec, s[56:57]
  buffer_load_dwordx4 v[140:143], v8, s[40:43], s67 offen sc1
  s_mov_b64 exec, -1
  v_lshlrev_b32 v64, 16, v176
  v_lshlrev_b32 v65, 16, v177
  v_lshlrev_b32 v66, 16, v178
  v_lshlrev_b32 v67, 16, v179
  v_and_b32 v68, 0xffff0000, v176
  v_and_b32 v69, 0xffff0000, v177
  v_and_b32 v70, 0xffff0000, v178
  v_and_b32 v71, 0xffff0000, v179
  s_branch Lpoll
  s_endpgm
Lfin:

.section .rodata,"a"
.p2align 6
.amdhsa_kernel standalone__deep_cross_pnn__recsys_kernel
  .amdhsa_next_free_vgpr 512
  .amdhsa_next_free_sgpr 102
  .amdhsa_accum_offset 256
  .amdhsa_group_segment_fixed_size 0
  .amdhsa_kernarg_size 80
  .amdhsa_user_sgpr_count 2
  .amdhsa_user_sgpr_kernarg_segment_ptr 1
  .amdhsa_system_sgpr_workgroup_id_x 1
.end_amdhsa_kernel
```
